```python
import torch

def _softmax(x, axis=-1):
    return torch.softmax(x, dim=axis)
def _gelu(x):
    return torch.nn.functional.gelu(x, approximate="tanh")
def _silu(x):
    return torch.nn.functional.silu(x)
def _sigmoid(x):
    return torch.sigmoid(x)
def _layernorm(x, axis=-1, eps=1e-5):
    m = x.mean(dim=axis, keepdim=True)
    v = x.var(dim=axis, keepdim=True, unbiased=False)
    return (x - m) / torch.sqrt(v + eps)
def _scatter_add(tgt, idx, src, axis=0):
    return tgt.clone().index_add_(axis, idx, src)
def _segment_sum(src, seg, n):
    out = torch.zeros((n,) + src.shape[1:], dtype=src.dtype)
    return out.index_add_(0, seg, src)
def _pad(x, pw):
    flat = tuple(v for pair in reversed(pw) for v in pair)
    return torch.nn.functional.pad(x, flat)

kernel_name = 'concat_heads__ssm_conv_s4__linear_kernel_hedgehog__prompt'

def setup_inputs():

    _w = (lambda a: (lambda t: t.to(torch.bfloat16) if t.is_floating_point() else t)(torch.as_tensor(a)))
    def _A_setup():
        B, L, D, N = 1, 2048, 640, 128
        A_re = -(lambda _x: torch.exp(torch.as_tensor(_x)))((lambda *s: torch.randn(*s, dtype=torch.bfloat16) * 3.2)(D, N))
        A_im = torch.pi * (lambda *s: torch.randn(*s, dtype=torch.bfloat16) * 0.2)(D, N)
        B_re = (lambda *s: torch.randn(*s, dtype=torch.bfloat16) * 0.4)(D, N)
        B_im = (lambda *s: torch.randn(*s, dtype=torch.bfloat16) * 0.4)(D, N)
        C_re = (lambda *s: torch.randn(*s, dtype=torch.bfloat16) * 0.4)(D, N)
        C_im = (lambda *s: torch.randn(*s, dtype=torch.bfloat16) * 0.4)(D, N)
        log_dt = (lambda *s: torch.randn(*s, dtype=torch.bfloat16) * 0.2)(D) * 0.5 - 4.0
        Dskip = (lambda *s: torch.randn(*s, dtype=torch.bfloat16) * 0.4)(D)
        return {
            "u": _w((lambda *s: torch.randn(*s, dtype=torch.bfloat16) * 0.05)(B, L, D)),
            "A_re": _w(A_re),
            "A_im": _w(A_im),
            "B_re": _w(B_re),
            "B_im": _w(B_im),
            "C_re": _w(C_re),
            "C_im": _w(C_im),
            "log_dt": _w(log_dt),
            "Dskip": _w(Dskip),
        }
    _A_in = _A_setup()

    def _B_setup():
        B, S, D, H = 1, 2048, 640, 32
        Dh = D // H
        return {
            "x": _w((lambda *s: torch.randn(*s, dtype=torch.bfloat16) * 0.4)(B, S, D)),
            "wqkv": _w((lambda *s: torch.randn(*s, dtype=torch.bfloat16) * 0.4)(D, 3 * D)),
            "w_phi": _w((lambda *s: torch.randn(*s, dtype=torch.bfloat16) * 0.4)(H, Dh, Dh) * (Dh ** -0.5)),
            "wo": _w((lambda *s: torch.randn(*s, dtype=torch.bfloat16) * 0.05)(D, D)),
        }
    _B_in = _B_setup()

    return {
        "A_u": _A_in["u"],
        "A_A_re": _A_in["A_re"],
        "A_A_im": _A_in["A_im"],
        "A_B_re": _A_in["B_re"],
        "A_B_im": _A_in["B_im"],
        "A_C_re": _A_in["C_re"],
        "A_C_im": _A_in["C_im"],
        "A_log_dt": _A_in["log_dt"],
        "A_Dskip": _A_in["Dskip"],
        "B_x": _B_in["x"],
        "B_wqkv": _B_in["wqkv"],
        "B_w_phi": _B_in["w_phi"],
        "B_wo": _B_in["wo"],
    }

def reference(A_u, A_A_re, A_A_im, A_B_re, A_B_im, A_C_re, A_C_im, A_log_dt, A_Dskip, B_x, B_wqkv, B_w_phi, B_wo):
    def _A_ref(u, A_re, A_im, B_re, B_im, C_re, C_im, log_dt, Dskip):
        Bsz, L, D = u.shape
        dt = torch.exp(log_dt)[:, None]
        A = A_re + 1j * A_im
        Bc = B_re + 1j * B_im
        Cc = C_re + 1j * C_im
        logdA = dt * A
        dB = dt * Bc
        l = (lambda x, dt: x.to(dt))(torch.arange(L), A_re.dtype)
        P = torch.exp(logdA[:, :, None] * l[None, None, :])
        K = torch.einsum("dn,dnl,dn->dl", Cc, P, dB).real
        L2 = 2 * L
        Kp = _pad(K, ((0, 0), (0, L)))
        up = (lambda x, *d: x.permute(*d))(u, 0, 2, 1)
        up = _pad(up, ((0, 0), (0, 0), (0, L)))
        Kf = (lambda x, axes=(-2,-1): torch.fft.rfft2(x.float(), dim=axes))(Kp[:, None, :], axes=(-2, -1))
        Uf = (lambda x, axes=(-2,-1): torch.fft.rfft2(x.float(), dim=axes))(up[:, :, None, :], axes=(-2, -1))
        Yf = Uf * Kf[None, :, :, :]
        y = (lambda x, s, axes=(-2,-1): torch.fft.irfft2(x, s=s, dim=axes).to(torch.bfloat16))(Yf, (1, L2), axes=(-2, -1))[:, :, 0, :L]
        y = (lambda x, *d: x.permute(*d))(y, 0, 2, 1) + u * Dskip[None, None, :]
        return y

    def _B_ref(x, wqkv, w_phi, wo):
        B, S, D = x.shape
        H = 32; Dh = D // H
        qkv = (lambda x, *d: x.permute(*d))((x @ wqkv).reshape(B, S, 3, H, Dh), 2, 0, 3, 1, 4)
        q, k, v = qkv[0], qkv[1], qkv[2]
        pq = torch.einsum("bhsd,hdf->bhsf", q, w_phi)
        pk = torch.einsum("bhsd,hdf->bhsf", k, w_phi)
        phi_q = torch.concatenate([_softmax(pq, axis=-1), _softmax(-pq, axis=-1)], axis=-1)
        phi_k = torch.concatenate([_softmax(pk, axis=-1), _softmax(-pk, axis=-1)], axis=-1)
        kv = torch.einsum("bhsf,bhsd->bhfd", phi_k, v)
        z  = torch.einsum("bhsf->bhf", phi_k)
        num = torch.einsum("bhqf,bhfd->bhqd", phi_q, kv)
        den = torch.einsum("bhqf,bhf->bhq", phi_q, z)[..., None] + 1e-6
        o = num / den
        return (lambda x, *d: x.permute(*d))(o, 0, 2, 1, 3).reshape(B, S, D) @ wo

    a = _A_ref(A_u, A_A_re, A_A_im, A_B_re, A_B_im, A_C_re, A_C_im, A_log_dt, A_Dskip)
    b = _B_ref(B_x, B_wqkv, B_w_phi, B_wo)
    return torch.concatenate([a, b], axis=-1)
```

```asm
; @launch grid=(416,1,1) block=(256,1,1) lds=81920
.amdgcn_target "amdgcn-amd-amdhsa--gfx950"
.text
.globl concat_heads__ssm_conv_s4__linear_kernel_hedgehog__prompt_kernel
.p2align 8
.type concat_heads__ssm_conv_s4__linear_kernel_hedgehog__prompt_kernel,@function
concat_heads__ssm_conv_s4__linear_kernel_hedgehog__prompt_kernel:
    s_cmp_ge_u32 s2, 160
    s_cbranch_scc1 L_Bsel
L_A:
    s_load_dwordx16 s[40:55], s[0:1], 0
    s_load_dwordx2 s[56:57], s[0:1], 64
    s_setprio 3
    s_and_b32 s8, s2, 7
    s_mul_i32 s8, s8, 20
    s_lshr_b32 s9, s2, 3
    s_add_u32 s36, s8, s9
    s_lshl_b32 s11, s36, 10
    v_lshl_add_u32 v3, v0, 2, s11
    v_lshrrev_b32 v4, 7, v3
    v_and_b32 v4, 0xfffe, v4
    s_getpc_b64 s[28:29]
    s_mul_i32 s9, s9, 1536
    v_lshrrev_b32 v5, 6, v0
    v_mul_u32_u24 v5, 61, v5
    v_sub_u32 v5, v0, v5
    v_lshl_add_u32 v5, v5, 7, s9
    v_mov_b32 v7, s29
    v_add_co_u32 v6, vcc, s28, v5
    s_nop 1
    v_addc_co_u32 v7, vcc, 0, v7, vcc
    s_mov_b64 exec, 7
    global_load_dword v55, v[6:7], off
    s_mov_b64 exec, -1
    s_waitcnt lgkmcnt(0)
    global_load_ushort v62, v4, s[54:55]
    global_load_dword v56, v3, s[42:43]
    global_load_dword v57, v3, s[44:45]
    global_load_dword v58, v3, s[46:47]
    global_load_dword v59, v3, s[48:49]
    global_load_dword v60, v3, s[50:51]
    global_load_dword v61, v3, s[52:53]
    global_load_ushort v63, v4, s[56:57]
    s_branch L_A2
L_Bsel:
    s_sub_u32 s2, s2, 160
    s_cmp_ge_u32 s2, 256
    s_cbranch_scc1 L_A_end
L_B:
    s_load_dwordx2 s[4:5], s[0:1], 0
    s_load_dwordx2 s[12:13], s[0:1], 80
    s_load_dwordx2 s[24:25], s[0:1], 96
    s_load_dwordx2 s[8:9], s[0:1], 72
    s_load_dwordx2 s[16:17], s[0:1], 120
    s_load_dwordx2 s[28:29], s[0:1], 88
    s_load_dwordx2 s[20:21], s[0:1], 104
    s_setprio 3
    v_lshrrev_b32 v12, 6, v0
    v_and_b32 v1, 63, v0
    v_readfirstlane_b32 s39, v12
    s_mov_b32 s14, 2457600
    s_mov_b32 s15, 0x00020000
    s_mov_b32 s26, 819200
    s_mov_b32 s27, 0x00020000
    s_and_b32 s40, s2, 7
    s_lshr_b32 s41, s2, 3
    s_and_b32 s36, s40, 1
    s_lshl_b32 s36, s36, 3
    s_add_u32 s42, s41, 20
    s_and_b32 s42, s42, 28
    s_lshr_b32 s59, 0x64317520, s42
    s_and_b32 s59, s59, 7
    s_add_u32 s36, s36, s59
    s_lshr_b32 s37, s40, 1
    s_lshl_b32 s37, s37, 2
    s_and_b32 s42, s41, 3
    s_add_u32 s37, s37, s42
    s_lshl_b32 s58, s40, 2
    s_add_u32 s58, s58, s42
    s_mul_i32 s38, s37, 3
    s_mul_i32 s40, s36, 4
    s_add_u32 s38, s38, s40
    s_mul_i32 s40, s38, 6554
    s_lshr_b32 s40, s40, 16
    s_mul_i32 s40, s40, 10
    s_sub_u32 s38, s38, s40
    s_mov_b32 s10, 2621440
    s_mov_b32 s11, 0x00020000
    v_lshrrev_b32 v14, 3, v1
    s_lshl_b32 s40, s37, 7
    s_lshl_b32 s41, s39, 5
    s_add_u32 s40, s40, s41
    v_add_u32 v14, s40, v14
    v_mul_u32_u24 v14, 1280, v14
    v_and_b32 v15, 7, v0
    v_lshrrev_b32 v12, 4, v1
    v_xor_b32 v15, v15, v12
    v_lshl_add_u32 v2, v15, 4, v14
    v_xor_b32 v15, 4, v15
    v_lshl_add_u32 v3, v15, 4, v14
    v_add_u32 v3, 10240, v3
    s_lshl_b32 s46, s39, 12
    s_add_u32 s46, s46, 46080
    s_lshl_b32 s47, s39, 10
    s_mul_i32 s48, s39, 768
    s_add_u32 s48, s48, 12288
    s_mul_i32 s43, s36, 80
    s_xor_b32 s45, s36, 1
    s_mul_i32 s45, s45, 80
    v_mov_b32 v27, s43
    v_mov_b32 v28, s45
    s_mul_i32 s44, s39, 48
    v_mul_u32_u24 v13, 13108, v0
    v_lshrrev_b32 v13, 16, v13
    v_mul_u32_u24 v14, 5, v13
    v_sub_u32 v12, v0, v14
    v_lshrrev_b32 v14, 1, v13
    v_lshrrev_b32 v15, 1, v14
    v_xor_b32 v15, v15, v14
    v_and_b32 v15, 4, v15
    v_mul_u32_u24 v15, 3, v15
    v_xor_b32 v14, v14, v15
    v_mul_u32_u24 v14, 3, v14
    v_and_b32 v15, 1, v13
    v_add_u32 v14, v14, v15
    v_mul_u32_u24 v14, 1280, v14
    v_lshl_add_u32 v14, v12, 4, v14
    v_and_b32 v15, 0x81, v13
    v_cmp_eq_u32 vcc, 0, v15
    s_nop 1
    v_cndmask_b32 v15, v27, v28, vcc
    v_add_u32 v4, v15, v14
    v_add_u32 v12, 256, v0
    v_mul_u32_u24 v13, 13108, v12
    v_lshrrev_b32 v13, 16, v13
    v_mul_u32_u24 v14, 5, v13
    v_sub_u32 v12, v12, v14
    v_lshrrev_b32 v14, 1, v13
    v_lshrrev_b32 v15, 1, v14
    v_xor_b32 v15, v15, v14
    v_and_b32 v15, 4, v15
    v_mul_u32_u24 v15, 3, v15
    v_xor_b32 v14, v14, v15
    v_mul_u32_u24 v14, 3, v14
    v_and_b32 v15, 1, v13
    v_add_u32 v14, v14, v15
    v_mul_u32_u24 v14, 1280, v14
    v_lshl_add_u32 v14, v12, 4, v14
    v_and_b32 v15, 0x81, v13
    v_cmp_eq_u32 vcc, 0, v15
    s_nop 1
    v_cndmask_b32 v15, v27, v28, vcc
    v_add_u32 v5, v15, v14
    v_add_u32 v12, 512, v0
    v_mul_u32_u24 v13, 13108, v12
    v_lshrrev_b32 v13, 16, v13
    v_mul_u32_u24 v14, 5, v13
    v_sub_u32 v12, v12, v14
    v_lshrrev_b32 v14, 1, v13
    v_lshrrev_b32 v15, 1, v14
    v_xor_b32 v15, v15, v14
    v_and_b32 v15, 4, v15
    v_mul_u32_u24 v15, 3, v15
    v_xor_b32 v14, v14, v15
    v_mul_u32_u24 v14, 3, v14
    v_and_b32 v15, 1, v13
    v_add_u32 v14, v14, v15
    v_and_b32 v24, 56, v13
    v_bfe_u32 v25, v13, 1, 2
    v_and_b32 v26, 1, v13
    v_lshl_add_u32 v25, v26, 2, v25
    v_add_u32 v24, v24, v25
    v_mul_u32_u24 v24, 3, v24
    v_add_u32 v24, 2, v24
    v_cmp_gt_u32 vcc, 128, v13
    s_nop 1
    v_cndmask_b32 v14, v24, v14, vcc
    v_mul_u32_u24 v14, 1280, v14
    v_lshl_add_u32 v14, v12, 4, v14
    v_and_b32 v15, 0x81, v13
    v_cmp_eq_u32 vcc, 0, v15
    s_nop 1
    v_cndmask_b32 v15, v27, v28, vcc
    v_add_u32 v6, v15, v14
    v_add_u32 v12, s44, v1
    v_add_u32 v12, 768, v12
    v_mul_u32_u24 v13, 13108, v12
    v_lshrrev_b32 v13, 16, v13
    v_mul_u32_u24 v14, 5, v13
    v_sub_u32 v12, v12, v14
    v_and_b32 v24, 56, v13
    v_bfe_u32 v25, v13, 1, 2
    v_and_b32 v26, 1, v13
    v_lshl_add_u32 v25, v26, 2, v25
    v_add_u32 v24, v24, v25
    v_mul_u32_u24 v24, 3, v24
    v_add_u32 v14, 2, v24
    v_mul_u32_u24 v14, 1280, v14
    v_lshl_add_u32 v14, v12, 4, v14
    v_add_u32 v7, s43, v14
    s_mov_b32 s6, 2621440
    s_mov_b32 s7, 0x00020000
    v_lshrrev_b32 v16, 3, v1
    v_mul_u32_u24 v16, 1280, v16
    v_and_b32 v17, 7, v1
    v_lshl_add_u32 v16, v17, 4, v16
    s_mul_i32 s49, s2, 10
    s_add_u32 s49, s49, s39
    s_mul_i32 s63, s39, 3072
    s_waitcnt lgkmcnt(0)
    s_add_u32 m0, s47, 0
    s_mul_i32 s60, s38, 245760
    buffer_load_dwordx4 v4, s[12:15], s60 offen lds
    s_add_u32 m0, s47, 4096
    s_nop 0
    buffer_load_dwordx4 v5, s[12:15], s60 offen lds
    s_add_u32 m0, s47, 8192
    s_nop 0
    buffer_load_dwordx4 v6, s[12:15], s60 offen lds
    s_add_u32 m0, s48, 0
    s_mov_b32 exec_hi, 0xffff
    buffer_load_dwordx4 v7, s[12:15], s60 offen lds
    s_mov_b32 exec_hi, -1
    s_lshl_b32 s51, s38, 7
    s_add_u32 m0, s46, 0
    s_add_u32 s52, s51, 20480
    buffer_load_dwordx4 v2, s[8:11], s51 offen lds
    s_add_u32 m0, s46, 1024
    s_add_u32 s38, s38, 1
    buffer_load_dwordx4 v3, s[8:11], s51 offen lds
    s_add_u32 m0, s46, 2048
    s_cmp_eq_u32 s38, 10
    buffer_load_dwordx4 v2, s[8:11], s52 offen lds
    s_cselect_b32 s38, 0, s38
    s_add_u32 m0, s46, 3072
    s_nop 0
    buffer_load_dwordx4 v3, s[8:11], s52 offen lds
    s_mov_b32 s18, 67108864
    s_mov_b32 s19, 0x00020000
    s_mov_b32 s22, 5242880
    s_mov_b32 s23, 0x00020000
    s_mov_b32 s30, 25600
    s_mov_b32 s31, 0x00020000
    s_add_u32 s54, s16, 7864320
    s_addc_u32 s55, s17, 0
    s_load_dword s62, s[54:55], 0
    s_mul_i32 s40, s2, 10
    s_add_u32 s41, s40, 9
    s_and_b32 s40, s40, 0xf00
    s_and_b32 s41, s41, 0xf00
    s_load_dword s61, s[54:55], s40 offset:256
    s_load_dword s53, s[54:55], s41 offset:256
    s_and_b32 s40, s39, 1
    s_mul_i32 s41, s40, 960
    s_add_u32 m0, s41, 78848
    s_lshl_b32 s42, s36, 1
    s_add_u32 s42, s42, s40
    s_mul_i32 s42, s42, 800
    v_lshlrev_b32 v238, 4, v1
    s_mov_b32 exec_hi, 0x3ffff
    buffer_load_dwordx4 v238, s[28:31], s42 offen lds
    s_mov_b64 exec, -1
    s_lshl_b32 s32, s36, 4
    s_add_u32 s32, s32, s37
    s_lshl_b32 s35, s36, 2
    s_add_u32 s35, s35, s39
    s_lshl_b32 s35, s35, 4
    s_add_u32 s35, s35, s37
    s_lshl_b32 s35, s35, 7
    s_add_u32 s35, s35, 7929856
    s_mul_i32 s32, s32, 4096
    s_lshl_b32 s40, s37, 3
    s_lshl_b32 s41, s39, 1
    s_add_u32 s40, s40, s41
    s_mul_i32 s40, s40, 20480
    s_add_u32 s40, s40, 1048576
    s_xor_b32 s41, s36, 1
    s_lshl_b32 s33, s41, 10
    s_add_u32 s33, s33, s40
    s_lshl_b32 s34, s41, 8
    s_add_u32 s34, s34, s40
    s_add_u32 s34, s34, 16384
    s_add_u32 s51, s49, 0
    s_and_b32 s52, s51, 255
    s_mul_i32 s52, s52, 10240
    s_lshr_b32 s51, s51, 8
    s_lshl_b32 s51, s51, 7
    s_add_u32 m0, s63, 30720
    s_add_u32 s51, s51, s52
    buffer_load_dwordx4 v16, s[4:7], s51 offen lds
    v_mov_b32 v48, 0
    v_mov_b32 v49, 0
    v_mov_b32 v50, 0
    v_mov_b32 v51, 0
    v_add_u32 v12, 80768, v238
    ds_write_b128 v12, v[48:51]
    v_and_b32 v180, 15, v0
    v_bfe_u32 v181, v0, 4, 2
    v_bfe_u32 v182, v0, 2, 2
    v_and_b32 v183, 3, v0
    v_lshrrev_b32 v15, 1, v180
    v_xor_b32 v15, v15, v181
    v_lshlrev_b32 v15, 4, v15
    v_lshl_add_u32 v15, v180, 7, v15
    v_add_u32 v8, s46, v15
    v_xor_b32 v9, 64, v8
    s_add_u32 s51, s49, 4
    s_and_b32 s52, s51, 255
    s_mul_i32 s52, s52, 10240
    s_lshr_b32 s51, s51, 8
    s_lshl_b32 s51, s51, 7
    s_add_u32 m0, s63, 31744
    s_add_u32 s51, s51, s52
    buffer_load_dwordx4 v16, s[4:7], s51 offen lds
    v_lshrrev_b32 v184, 1, v181
    v_and_b32 v185, 1, v181
    v_lshlrev_b32 v15, 4, v184
    v_lshl_add_u32 v15, v185, 2, v15
    v_add_u32 v15, v15, v182
    v_mul_u32_u24 v15, 160, v15
    v_mul_u32_u24 v186, 40, v183
    v_add_u32 v10, v15, v186
    v_lshrrev_b32 v187, 2, v1
    v_mul_u32_u24 v15, 160, v187
    v_lshl_add_u32 v11, v183, 3, v15
    v_cmp_eq_u32 vcc, v181, v183
    v_mul_u32_u24 v246, 960, v185
    v_mul_u32_u24 v15, 40, v182
    v_add_u32 v246, v246, v15
    v_add_u32 v246, 78848, v246
    s_add_u32 s51, s49, 8
    s_and_b32 s52, s51, 255
    s_mul_i32 s52, s52, 10240
    s_lshr_b32 s51, s51, 8
    s_lshl_b32 s51, s51, 7
    s_add_u32 m0, s63, 32768
    s_add_u32 s51, s51, s52
    s_cmp_ge_u32 s39, 2
    s_cselect_b32 s51, 1073741824, s51
    buffer_load_dwordx4 v16, s[4:7], s51 offen lds
    v_mov_b32 v188, 80768
    v_cndmask_b32 v246, v188, v246, vcc
    s_lshl_b32 s41, s39, 5
    v_add_u32 v15, s41, v180
    v_mul_u32_u24 v226, 96, v15
    v_lshl_add_u32 v226, v181, 3, v226
    v_lshl_add_u32 v15, v184, 4, v15
    v_mul_u32_u24 v227, 160, v15
    v_mul_u32_u24 v14, 80, v185
    v_add_u32 v227, v227, v14
    s_lshr_b32 s40, s39, 1
    s_and_b32 s41, s39, 1
    s_mul_i32 s42, s40, 40
    s_lshl_b32 s43, s41, 5
    s_add_u32 s43, s43, s42
    s_lshl_b32 s42, s42, 1
    s_add_u32 m0, s47, 15360
    s_mul_i32 s60, s38, 245760
    buffer_load_dwordx4 v4, s[12:15], s60 offen lds
    v_lshlrev_b32 v14, 3, v183
    v_mul_u32_u24 v228, 96, v187
    v_add3_u32 v228, v228, v14, s43
    v_add_u32 v229, s42, v11
    s_cmp_eq_u32 s41, 1
    s_cselect_b32 s56, 0xfff0fff0, 0
    s_mov_b32 s57, s56
    s_mul_i32 s40, s40, 1920
    s_lshl_b32 s42, s41, 10
    s_add_u32 s42, s42, s40
    s_lshl_b32 s43, s41, 8
    s_add_u32 s43, s43, s40
    s_add_u32 s43, s43, 1536
    s_lshr_b32 s41, 64, s41
    v_mov_b32 v189, 1073741824
    v_add_u32 v14, s42, v238
    s_add_u32 m0, s47, 19456
    s_nop 0
    buffer_load_dwordx4 v5, s[12:15], s60 offen lds
    v_cmp_gt_u32 vcc, s41, v1
    s_nop 1
    v_cndmask_b32 v230, v189, v14, vcc
    v_lshlrev_b32 v14, 6, v181
    v_lshl_add_u32 v14, v180, 3, v14
    v_add_u32 v14, s43, v14
    v_cndmask_b32 v14, v189, v14, vcc
    v_and_b32 v15, 9, v1
    v_cmp_eq_u32 vcc, 0, v15
    s_nop 1
    v_cndmask_b32 v231, v189, v14, vcc
    v_mul_u32_u24 v14, 6554, v1
    v_lshrrev_b32 v14, 16, v14
    v_mul_u32_u24 v15, 10, v14
    v_sub_u32 v15, v1, v15
    s_mul_i32 s40, s39, 5
    v_add_u32 v14, s40, v14
    v_mul_u32_u24 v14, 1280, v14
    s_add_u32 m0, s47, 23552
    s_nop 0
    buffer_load_dwordx4 v6, s[12:15], s60 offen lds
    v_lshl_add_u32 v14, v15, 4, v14
    s_mul_i32 s40, s59, 160
    v_add_u32 v232, s40, v14
    v_mov_b32 v233, 0x3f803f80
    s_xor_b32 s40, s36, 1
    s_lshl_b32 s40, s40, 2
    s_add_u32 s40, s40, s39
    s_lshl_b32 s40, s40, 11
    s_add_u32 s40, s40, 7929856
    v_lshl_add_u32 v234, v180, 7, s40
    s_lshl_b32 s40, s58, 1
    s_lshr_b32 s41, s39, 1
    s_add_u32 s40, s40, s41
    s_lshl_b32 s40, s40, 11
    s_add_u32 s40, s40, 8060928
    v_lshl_add_u32 v244, v180, 7, s40
    s_add_u32 m0, s48, 15360
    s_mov_b32 exec_hi, 0xffff
    buffer_load_dwordx4 v7, s[12:15], s60 offen lds
    s_mov_b32 exec_hi, -1
    v_cmp_eq_u32 vcc, 0, v185
    v_mul_u32_u24 v14, 20480, v184
    v_lshl_add_u32 v14, v180, 4, v14
    v_cndmask_b32 v239, v189, v14, vcc
    v_lshlrev_b32 v190, 4, v0
    v_cmp_gt_u32 vcc, 240, v0
    s_nop 1
    v_cndmask_b32 v235, v189, v190, vcc
    v_cmp_eq_u32 vcc, 0, v0
    s_nop 1
    v_cndmask_b32 v245, v189, v0, vcc
    v_cmp_le_u32 vcc, 120, v0
    v_subrev_u32 v13, 120, v0
    s_nop 0
    v_cndmask_b32 v13, v0, v13, vcc
    v_mov_b32 v14, 76800
    v_mov_b32 v15, 78720
    v_cndmask_b32 v192, v14, v15, vcc
    v_lshrrev_b32 v14, 4, v13
    s_lshl_b32 s51, s38, 7
    s_add_u32 m0, s46, 16384
    s_add_u32 s52, s51, 20480
    buffer_load_dwordx4 v2, s[8:11], s51 offen lds
    v_and_b32 v15, 15, v13
    v_mul_u32_u24 v15, 48, v15
    v_lshl_add_u32 v14, v14, 3, v15
    v_subrev_u32 v193, 96, v13
    v_lshrrev_b32 v15, 2, v193
    v_and_b32 v193, 3, v193
    v_mul_u32_u24 v193, 96, v193
    v_lshl_add_u32 v15, v15, 3, v193
    v_add_u32 v15, 1536, v15
    v_cmp_gt_u32 vcc, 96, v13
    s_nop 1
    v_cndmask_b32 v14, v15, v14, vcc
    v_add_u32 v236, v192, v14
    v_mov_b32 v15, 768
    v_cndmask_b32 v15, 48, v15, vcc
    v_add_u32 v12, v236, v15
    v_bfe_u32 v13, v0, 1, 1
    s_add_u32 m0, s46, 17408
    s_add_u32 s38, s38, 1
    buffer_load_dwordx4 v3, s[8:11], s51 offen lds
    v_cmp_eq_u32 vcc, v185, v13
    v_mul_u32_u24 v14, 40, v185
    v_mul_u32_u24 v15, 20, v184
    v_add3_u32 v14, v14, v15, v182
    v_mul_u32_u24 v14, 48, v14
    v_and_b32 v191, 1, v0
    v_mul_u32_u24 v13, 24, v191
    v_add_u32 v14, v14, v13
    v_add_u32 v14, 76800, v14
    v_cndmask_b32 v237, v188, v14, vcc
    v_mul_u32_u24 v14, 12, v185
    v_add3_u32 v14, v14, v15, v182
    v_mul_u32_u24 v14, 160, v14
    v_add_u32 v240, v14, v186
    v_mul_u32_u24 v13, 40, v181
    v_add3_u32 v14, v13, v182, 8
    s_add_u32 m0, s46, 18432
    s_cmp_eq_u32 s38, 10
    buffer_load_dwordx4 v2, s[8:11], s52 offen lds
    s_cselect_b32 s38, 0, s38
    v_mul_u32_u24 v14, 160, v14
    v_add_u32 v241, v14, v186
    s_lshl_b32 s40, s58, 2
    s_add_u32 s40, s40, s39
    s_lshl_b32 s41, s40, 4
    v_add_u32 v14, s41, v180
    v_mul_u32_u24 v14, 2560, v14
    s_mul_i32 s41, s59, 160
    s_add_u32 s41, s41, 1280
    v_add3_u32 v242, v14, v13, s41
    s_mul_i32 s3, s40, 20480
    s_add_u32 s3, s3, 1048576
    v_cmp_eq_u32 vcc, 0, v1
    s_nop 1
    v_cndmask_b32 v243, v189, v1, vcc
    v_cmp_eq_u32 vcc, v181, v182
    v_mov_b32 v14, 0x3f80
    s_add_u32 m0, s46, 19456
    s_nop 0
    buffer_load_dwordx4 v3, s[8:11], s52 offen lds
    v_lshlrev_b32 v15, 4, v191
    v_lshlrev_b32 v14, v15, v14
    v_cndmask_b32 v14, 0, v14, vcc
    v_cmp_gt_u32 vcc, 2, v183
    s_nop 1
    v_cndmask_b32 v250, 0, v14, vcc
    v_cndmask_b32 v251, v14, 0, vcc
    s_mov_b32 s50, 0x3fb8aa3b
    s_mul_i32 s49, s49, 1024
    s_add_u32 s49, s49, 4194304
    v_lshlrev_b32 v16, 7, v182
    v_lshl_add_u32 v16, v181, 5, v16
    v_lshl_add_u32 v16, v183, 3, v16
    v_add_u32 v16, s63, v16
    s_waitcnt vmcnt(8) lgkmcnt(0)
    s_add_u32 s62, s62, 1
    s_cmp_eq_u32 s62, -1
    s_cselect_b32 s62, 0, s62
    v_mov_b32 v249, s62
    s_add_u32 s61, s61, 1
    s_cmp_eq_u32 s61, -1
    s_cselect_b32 s61, 0, s61
    s_add_u32 s53, s53, 1
    s_cmp_eq_u32 s53, -1
    s_cselect_b32 s53, 0, s53
    v_mov_b32 v247, s61
    v_mov_b32 v248, s53
    ds_read_b64_tr_b16 v[214:215], v16 offset:30720
    ds_read_b64_tr_b16 v[216:217], v16 offset:31232
    ds_read_b64_tr_b16 v[218:219], v16 offset:31744
    ds_read_b64_tr_b16 v[220:221], v16 offset:32256
    ds_read_b64_tr_b16 v[222:223], v16 offset:32768
    ds_read_b64_tr_b16 v[224:225], v16 offset:33280
    s_mov_b32 s6, s49
    s_add_u32 s7, s6, 8192
    s_cmp_ge_u32 s39, 2
    s_cselect_b32 s7, 1073741824, s7
    s_add_u32 s63, s6, 4096
    s_waitcnt lgkmcnt(0)
    s_lshl_b32 s49, s2, 8
    s_add_u32 s49, s49, 7471104
    s_waitcnt vmcnt(8)
    s_barrier
    ds_read_b128 v[144:147], v8 offset:0
    ds_read_b128 v[148:151], v8 offset:2048
    ds_read_b128 v[152:155], v9 offset:0
    ds_read_b128 v[156:159], v9 offset:2048
    ds_read_b64_tr_b16 v[80:81], v10 offset:0
    ds_read_b64_tr_b16 v[82:83], v10 offset:1280
    ds_read_b64_tr_b16 v[84:85], v10 offset:8
    ds_read_b64_tr_b16 v[86:87], v10 offset:1288
    ds_read_b64_tr_b16 v[88:89], v10 offset:16
    ds_read_b64_tr_b16 v[90:91], v10 offset:1296
    ds_read_b64_tr_b16 v[92:93], v10 offset:24
    ds_read_b64_tr_b16 v[94:95], v10 offset:1304
    ds_read_b64_tr_b16 v[96:97], v10 offset:32
    ds_read_b64_tr_b16 v[98:99], v10 offset:1312
    ds_read_b64_tr_b16 v[100:101], v11 offset:10240
    ds_read_b64_tr_b16 v[102:103], v11 offset:10320
    ds_read_b64_tr_b16 v[104:105], v11 offset:10272
    ds_read_b64_tr_b16 v[106:107], v11 offset:10352
    ds_read_b64_tr_b16 v[108:109], v11 offset:10304
    ds_read_b64_tr_b16 v[110:111], v11 offset:10384
    s_add_u32 m0, s47, 30720
    s_mul_i32 s60, s38, 245760
    buffer_load_dwordx4 v4, s[12:15], s60 offen lds
    s_add_u32 m0, s47, 34816
    s_nop 0
    buffer_load_dwordx4 v5, s[12:15], s60 offen lds
    s_add_u32 m0, s47, 38912
    s_nop 0
    buffer_load_dwordx4 v6, s[12:15], s60 offen lds
    s_add_u32 m0, s48, 30720
    s_mov_b32 exec_hi, 0xffff
    buffer_load_dwordx4 v7, s[12:15], s60 offen lds
    s_mov_b32 exec_hi, -1
    s_waitcnt lgkmcnt(0)
    v_mfma_f32_16x16x32_bf16 v[16:19], v[80:83], v[144:147], 0
    ds_read_b64_tr_b16 v[112:113], v10 offset:5120
    ds_read_b64_tr_b16 v[114:115], v10 offset:6400
    v_mfma_f32_16x16x32_bf16 v[20:23], v[80:83], v[148:151], 0
    ds_read_b64_tr_b16 v[116:117], v10 offset:5128
    ds_read_b64_tr_b16 v[118:119], v10 offset:6408
    v_mfma_f32_16x16x32_bf16 v[24:27], v[84:87], v[144:147], 0
    ds_read_b64_tr_b16 v[120:121], v10 offset:5136
    ds_read_b64_tr_b16 v[122:123], v10 offset:6416
    v_mfma_f32_16x16x32_bf16 v[28:31], v[84:87], v[148:151], 0
    ds_read_b64_tr_b16 v[124:125], v10 offset:5144
    ds_read_b64_tr_b16 v[126:127], v10 offset:6424
    v_mfma_f32_16x16x32_bf16 v[32:35], v[88:91], v[144:147], 0
    ds_read_b64_tr_b16 v[128:129], v10 offset:5152
    ds_read_b64_tr_b16 v[130:131], v10 offset:6432
    v_mfma_f32_16x16x32_bf16 v[36:39], v[88:91], v[148:151], 0
    ds_read_b64_tr_b16 v[132:133], v11 offset:12800
    ds_read_b64_tr_b16 v[134:135], v11 offset:12880
    v_mfma_f32_16x16x32_bf16 v[40:43], v[92:95], v[144:147], 0
    ds_read_b64_tr_b16 v[136:137], v11 offset:12832
    ds_read_b64_tr_b16 v[138:139], v11 offset:12912
    v_mfma_f32_16x16x32_bf16 v[44:47], v[92:95], v[148:151], 0
    ds_read_b64_tr_b16 v[140:141], v11 offset:12864
    ds_read_b64_tr_b16 v[142:143], v11 offset:12944
    v_mfma_f32_16x16x32_bf16 v[48:51], v[96:99], v[144:147], 0
    s_lshl_b32 s51, s38, 7
    s_add_u32 m0, s46, 0
    s_add_u32 s52, s51, 20480
    buffer_load_dwordx4 v2, s[8:11], s51 offen lds
    v_mfma_f32_16x16x32_bf16 v[52:55], v[96:99], v[148:151], 0
    s_add_u32 m0, s46, 1024
    s_add_u32 s38, s38, 1
    buffer_load_dwordx4 v3, s[8:11], s51 offen lds
    v_mfma_f32_16x16x32_bf16 v[56:59], v[100:103], v[144:147], 0
    s_add_u32 m0, s46, 2048
    s_cmp_eq_u32 s38, 10
    buffer_load_dwordx4 v2, s[8:11], s52 offen lds
    s_cselect_b32 s38, 0, s38
    v_mfma_f32_16x16x32_bf16 v[60:63], v[100:103], v[148:151], 0
    s_add_u32 m0, s46, 3072
    s_nop 0
    buffer_load_dwordx4 v3, s[8:11], s52 offen lds
    v_mfma_f32_16x16x32_bf16 v[64:67], v[104:107], v[144:147], 0
    buffer_store_dwordx4 v[214:217], v238, s[16:19], s6 offen sc1
    v_mfma_f32_16x16x32_bf16 v[68:71], v[104:107], v[148:151], 0
    buffer_store_dwordx4 v[218:221], v238, s[16:19], s63 offen sc1
    v_mfma_f32_16x16x32_bf16 v[72:75], v[108:111], v[144:147], 0
    buffer_store_dwordx4 v[222:225], v238, s[16:19], s7 offen sc1
    v_mfma_f32_16x16x32_bf16 v[76:79], v[108:111], v[148:151], 0
    s_waitcnt lgkmcnt(0)
    s_waitcnt vmcnt(11)
    s_barrier
    v_mfma_f32_16x16x32_bf16 v[16:19], v[112:115], v[152:155], v[16:19]
    ds_read_b128 v[160:163], v8 offset:16384
    ds_read_b128 v[164:167], v8 offset:18432
    v_mfma_f32_16x16x32_bf16 v[20:23], v[112:115], v[156:159], v[20:23]
    ds_read_b128 v[168:171], v9 offset:16384
    ds_read_b128 v[172:175], v9 offset:18432
    v_mfma_f32_16x16x32_bf16 v[24:27], v[116:119], v[152:155], v[24:27]
    ds_read_b64_tr_b16 v[80:81], v10 offset:15360
    ds_read_b64_tr_b16 v[82:83], v10 offset:16640
    v_mfma_f32_16x16x32_bf16 v[28:31], v[116:119], v[156:159], v[28:31]
    ds_read_b64_tr_b16 v[84:85], v10 offset:15368
    ds_read_b64_tr_b16 v[86:87], v10 offset:16648
    v_mfma_f32_16x16x32_bf16 v[32:35], v[120:123], v[152:155], v[32:35]
    ds_read_b64_tr_b16 v[88:89], v10 offset:15376
    ds_read_b64_tr_b16 v[90:91], v10 offset:16656
    v_mfma_f32_16x16x32_bf16 v[36:39], v[120:123], v[156:159], v[36:39]
    ds_read_b64_tr_b16 v[92:93], v10 offset:15384
    ds_read_b64_tr_b16 v[94:95], v10 offset:16664
    v_mfma_f32_16x16x32_bf16 v[40:43], v[124:127], v[152:155], v[40:43]
    ds_read_b64_tr_b16 v[96:97], v10 offset:15392
    ds_read_b64_tr_b16 v[98:99], v10 offset:16672
    v_mfma_f32_16x16x32_bf16 v[44:47], v[124:127], v[156:159], v[44:47]
    ds_read_b64_tr_b16 v[100:101], v11 offset:25600
    ds_read_b64_tr_b16 v[102:103], v11 offset:25680
    v_mfma_f32_16x16x32_bf16 v[48:51], v[128:131], v[152:155], v[48:51]
    ds_read_b64_tr_b16 v[104:105], v11 offset:25632
    ds_read_b64_tr_b16 v[106:107], v11 offset:25712
    v_mfma_f32_16x16x32_bf16 v[52:55], v[128:131], v[156:159], v[52:55]
    ds_read_b64_tr_b16 v[108:109], v11 offset:25664
    ds_read_b64_tr_b16 v[110:111], v11 offset:25744
    v_mfma_f32_16x16x32_bf16 v[56:59], v[132:135], v[152:155], v[56:59]
    s_add_u32 m0, s47, 0
    s_mul_i32 s60, s38, 245760
    buffer_load_dwordx4 v4, s[12:15], s60 offen lds
    v_mfma_f32_16x16x32_bf16 v[60:63], v[132:135], v[156:159], v[60:63]
    s_add_u32 m0, s47, 4096
    s_nop 0
    buffer_load_dwordx4 v5, s[12:15], s60 offen lds
    v_mfma_f32_16x16x32_bf16 v[64:67], v[136:139], v[152:155], v[64:67]
    s_add_u32 m0, s47, 8192
    s_nop 0
    buffer_load_dwordx4 v6, s[12:15], s60 offen lds
    v_mfma_f32_16x16x32_bf16 v[68:71], v[136:139], v[156:159], v[68:71]
    s_add_u32 m0, s48, 0
    s_mov_b32 exec_hi, 0xffff
    buffer_load_dwordx4 v7, s[12:15], s60 offen lds
    s_mov_b32 exec_hi, -1
    v_mfma_f32_16x16x32_bf16 v[72:75], v[140:143], v[152:155], v[72:75]
    v_mfma_f32_16x16x32_bf16 v[76:79], v[140:143], v[156:159], v[76:79]
    s_waitcnt lgkmcnt(0)
    v_mfma_f32_16x16x32_bf16 v[16:19], v[80:83], v[160:163], v[16:19]
    ds_read_b64_tr_b16 v[112:113], v10 offset:20480
    ds_read_b64_tr_b16 v[114:115], v10 offset:21760
    v_mfma_f32_16x16x32_bf16 v[20:23], v[80:83], v[164:167], v[20:23]
    ds_read_b64_tr_b16 v[116:117], v10 offset:20488
    ds_read_b64_tr_b16 v[118:119], v10 offset:21768
    v_mfma_f32_16x16x32_bf16 v[24:27], v[84:87], v[160:163], v[24:27]
    ds_read_b64_tr_b16 v[120:121], v10 offset:20496
    ds_read_b64_tr_b16 v[122:123], v10 offset:21776
    v_mfma_f32_16x16x32_bf16 v[28:31], v[84:87], v[164:167], v[28:31]
    ds_read_b64_tr_b16 v[124:125], v10 offset:20504
    ds_read_b64_tr_b16 v[126:127], v10 offset:21784
    v_mfma_f32_16x16x32_bf16 v[32:35], v[88:91], v[160:163], v[32:35]
    ds_read_b64_tr_b16 v[128:129], v10 offset:20512
    ds_read_b64_tr_b16 v[130:131], v10 offset:21792
    v_mfma_f32_16x16x32_bf16 v[36:39], v[88:91], v[164:167], v[36:39]
    ds_read_b64_tr_b16 v[132:133], v11 offset:28160
    ds_read_b64_tr_b16 v[134:135], v11 offset:28240
    v_mfma_f32_16x16x32_bf16 v[40:43], v[92:95], v[160:163], v[40:43]
    ds_read_b64_tr_b16 v[136:137], v11 offset:28192
    ds_read_b64_tr_b16 v[138:139], v11 offset:28272
    v_mfma_f32_16x16x32_bf16 v[44:47], v[92:95], v[164:167], v[44:47]
    ds_read_b64_tr_b16 v[140:141], v11 offset:28224
    ds_read_b64_tr_b16 v[142:143], v11 offset:28304
    v_mfma_f32_16x16x32_bf16 v[48:51], v[96:99], v[160:163], v[48:51]
    s_lshl_b32 s51, s38, 7
    s_add_u32 m0, s46, 16384
    s_add_u32 s52, s51, 20480
    buffer_load_dwordx4 v2, s[8:11], s51 offen lds
    v_mfma_f32_16x16x32_bf16 v[52:55], v[96:99], v[164:167], v[52:55]
    s_add_u32 m0, s46, 17408
    s_add_u32 s38, s38, 1
    buffer_load_dwordx4 v3, s[8:11], s51 offen lds
    v_mfma_f32_16x16x32_bf16 v[56:59], v[100:103], v[160:163], v[56:59]
    s_add_u32 m0, s46, 18432
    s_cmp_eq_u32 s38, 10
    buffer_load_dwordx4 v2, s[8:11], s52 offen lds
    s_cselect_b32 s38, 0, s38
    v_mfma_f32_16x16x32_bf16 v[60:63], v[100:103], v[164:167], v[60:63]
    s_add_u32 m0, s46, 19456
    s_nop 0
    buffer_load_dwordx4 v3, s[8:11], s52 offen lds
    v_mfma_f32_16x16x32_bf16 v[64:67], v[104:107], v[160:163], v[64:67]
    v_mfma_f32_16x16x32_bf16 v[68:71], v[104:107], v[164:167], v[68:71]
    v_mfma_f32_16x16x32_bf16 v[72:75], v[108:111], v[160:163], v[72:75]
    v_mfma_f32_16x16x32_bf16 v[76:79], v[108:111], v[164:167], v[76:79]
    s_waitcnt lgkmcnt(0)
    s_waitcnt vmcnt(11)
    s_barrier
    v_mfma_f32_16x16x32_bf16 v[16:19], v[112:115], v[168:171], v[16:19]
    ds_read_b128 v[144:147], v8 offset:0
    ds_read_b128 v[148:151], v8 offset:2048
    v_mfma_f32_16x16x32_bf16 v[20:23], v[112:115], v[172:175], v[20:23]
    ds_read_b128 v[152:155], v9 offset:0
    ds_read_b128 v[156:159], v9 offset:2048
    v_mfma_f32_16x16x32_bf16 v[24:27], v[116:119], v[168:171], v[24:27]
    ds_read_b64_tr_b16 v[80:81], v10 offset:30720
    ds_read_b64_tr_b16 v[82:83], v10 offset:32000
    v_mfma_f32_16x16x32_bf16 v[28:31], v[116:119], v[172:175], v[28:31]
    ds_read_b64_tr_b16 v[84:85], v10 offset:30728
    ds_read_b64_tr_b16 v[86:87], v10 offset:32008
    v_mfma_f32_16x16x32_bf16 v[32:35], v[120:123], v[168:171], v[32:35]
    ds_read_b64_tr_b16 v[88:89], v10 offset:30736
    ds_read_b64_tr_b16 v[90:91], v10 offset:32016
    v_mfma_f32_16x16x32_bf16 v[36:39], v[120:123], v[172:175], v[36:39]
    ds_read_b64_tr_b16 v[92:93], v10 offset:30744
    ds_read_b64_tr_b16 v[94:95], v10 offset:32024
    v_mfma_f32_16x16x32_bf16 v[40:43], v[124:127], v[168:171], v[40:43]
    ds_read_b64_tr_b16 v[96:97], v10 offset:30752
    ds_read_b64_tr_b16 v[98:99], v10 offset:32032
    v_mfma_f32_16x16x32_bf16 v[44:47], v[124:127], v[172:175], v[44:47]
    ds_read_b64_tr_b16 v[100:101], v11 offset:40960
    ds_read_b64_tr_b16 v[102:103], v11 offset:41040
    v_mfma_f32_16x16x32_bf16 v[48:51], v[128:131], v[168:171], v[48:51]
    ds_read_b64_tr_b16 v[104:105], v11 offset:40992
    ds_read_b64_tr_b16 v[106:107], v11 offset:41072
    v_mfma_f32_16x16x32_bf16 v[52:55], v[128:131], v[172:175], v[52:55]
    ds_read_b64_tr_b16 v[108:109], v11 offset:41024
    ds_read_b64_tr_b16 v[110:111], v11 offset:41104
    v_mfma_f32_16x16x32_bf16 v[56:59], v[132:135], v[168:171], v[56:59]
    s_add_u32 m0, s47, 15360
    s_mul_i32 s60, s38, 245760
    buffer_load_dwordx4 v4, s[12:15], s60 offen lds
    v_mfma_f32_16x16x32_bf16 v[60:63], v[132:135], v[172:175], v[60:63]
    s_add_u32 m0, s47, 19456
    s_nop 0
    buffer_load_dwordx4 v5, s[12:15], s60 offen lds
    v_mfma_f32_16x16x32_bf16 v[64:67], v[136:139], v[168:171], v[64:67]
    s_add_u32 m0, s47, 23552
    s_nop 0
    buffer_load_dwordx4 v6, s[12:15], s60 offen lds
    v_mfma_f32_16x16x32_bf16 v[68:71], v[136:139], v[172:175], v[68:71]
    s_add_u32 m0, s48, 15360
    s_mov_b32 exec_hi, 0xffff
    buffer_load_dwordx4 v7, s[12:15], s60 offen lds
    s_mov_b32 exec_hi, -1
    v_mfma_f32_16x16x32_bf16 v[72:75], v[140:143], v[168:171], v[72:75]
    v_mfma_f32_16x16x32_bf16 v[76:79], v[140:143], v[172:175], v[76:79]
    s_waitcnt lgkmcnt(0)
    v_mfma_f32_16x16x32_bf16 v[16:19], v[80:83], v[144:147], v[16:19]
    ds_read_b64_tr_b16 v[112:113], v10 offset:35840
    ds_read_b64_tr_b16 v[114:115], v10 offset:37120
    v_mfma_f32_16x16x32_bf16 v[20:23], v[80:83], v[148:151], v[20:23]
    ds_read_b64_tr_b16 v[116:117], v10 offset:35848
    ds_read_b64_tr_b16 v[118:119], v10 offset:37128
    v_mfma_f32_16x16x32_bf16 v[24:27], v[84:87], v[144:147], v[24:27]
    ds_read_b64_tr_b16 v[120:121], v10 offset:35856
    ds_read_b64_tr_b16 v[122:123], v10 offset:37136
    v_mfma_f32_16x16x32_bf16 v[28:31], v[84:87], v[148:151], v[28:31]
    ds_read_b64_tr_b16 v[124:125], v10 offset:35864
    ds_read_b64_tr_b16 v[126:127], v10 offset:37144
    v_mfma_f32_16x16x32_bf16 v[32:35], v[88:91], v[144:147], v[32:35]
    ds_read_b64_tr_b16 v[128:129], v10 offset:35872
    ds_read_b64_tr_b16 v[130:131], v10 offset:37152
    v_mfma_f32_16x16x32_bf16 v[36:39], v[88:91], v[148:151], v[36:39]
    ds_read_b64_tr_b16 v[132:133], v11 offset:43520
    ds_read_b64_tr_b16 v[134:135], v11 offset:43600
    v_mfma_f32_16x16x32_bf16 v[40:43], v[92:95], v[144:147], v[40:43]
    ds_read_b64_tr_b16 v[136:137], v11 offset:43552
    ds_read_b64_tr_b16 v[138:139], v11 offset:43632
    v_mfma_f32_16x16x32_bf16 v[44:47], v[92:95], v[148:151], v[44:47]
    ds_read_b64_tr_b16 v[140:141], v11 offset:43584
    ds_read_b64_tr_b16 v[142:143], v11 offset:43664
    v_mfma_f32_16x16x32_bf16 v[48:51], v[96:99], v[144:147], v[48:51]
    s_lshl_b32 s51, s38, 7
    s_add_u32 m0, s46, 0
    s_add_u32 s52, s51, 20480
    buffer_load_dwordx4 v2, s[8:11], s51 offen lds
    v_mfma_f32_16x16x32_bf16 v[52:55], v[96:99], v[148:151], v[52:55]
    s_add_u32 m0, s46, 1024
    s_add_u32 s38, s38, 1
    buffer_load_dwordx4 v3, s[8:11], s51 offen lds
    v_mfma_f32_16x16x32_bf16 v[56:59], v[100:103], v[144:147], v[56:59]
    s_add_u32 m0, s46, 2048
    s_cmp_eq_u32 s38, 10
    buffer_load_dwordx4 v2, s[8:11], s52 offen lds
    s_cselect_b32 s38, 0, s38
    v_mfma_f32_16x16x32_bf16 v[60:63], v[100:103], v[148:151], v[60:63]
    s_add_u32 m0, s46, 3072
    s_nop 0
    buffer_load_dwordx4 v3, s[8:11], s52 offen lds
    v_mfma_f32_16x16x32_bf16 v[64:67], v[104:107], v[144:147], v[64:67]
    ds_read_b64_tr_b16 v[176:177], v246 offset:0
    ds_read_b64_tr_b16 v[178:179], v246 offset:160
    v_mfma_f32_16x16x32_bf16 v[68:71], v[104:107], v[148:151], v[68:71]
    ds_read_b64_tr_b16 v[180:181], v246 offset:320
    ds_read_b64_tr_b16 v[182:183], v246 offset:480
    v_mfma_f32_16x16x32_bf16 v[72:75], v[108:111], v[144:147], v[72:75]
    ds_read_b64_tr_b16 v[184:185], v246 offset:640
    ds_read_b64_tr_b16 v[186:187], v246 offset:8
    v_mfma_f32_16x16x32_bf16 v[76:79], v[108:111], v[148:151], v[76:79]
    ds_read_b64_tr_b16 v[188:189], v246 offset:168
    ds_read_b64_tr_b16 v[190:191], v246 offset:328
    ds_read_b64_tr_b16 v[192:193], v246 offset:488
    ds_read_b64_tr_b16 v[194:195], v246 offset:648
    ds_read_b64_tr_b16 v[196:197], v246 offset:16
    ds_read_b64_tr_b16 v[198:199], v246 offset:176
    ds_read_b64_tr_b16 v[200:201], v246 offset:336
    ds_read_b64_tr_b16 v[202:203], v246 offset:496
    ds_read_b64_tr_b16 v[204:205], v246 offset:656
    s_waitcnt lgkmcnt(0)
    s_waitcnt vmcnt(8)
    s_barrier
    v_mfma_f32_16x16x32_bf16 v[16:19], v[112:115], v[152:155], v[16:19]
    ds_read_b128 v[160:163], v8 offset:16384
    ds_read_b128 v[164:167], v8 offset:18432
    v_mfma_f32_16x16x32_bf16 v[20:23], v[112:115], v[156:159], v[20:23]
    ds_read_b128 v[168:171], v9 offset:16384
    ds_read_b128 v[172:175], v9 offset:18432
    v_mfma_f32_16x16x32_bf16 v[24:27], v[116:119], v[152:155], v[24:27]
    ds_read_b64_tr_b16 v[80:81], v10 offset:0
    ds_read_b64_tr_b16 v[82:83], v10 offset:1280
    v_mfma_f32_16x16x32_bf16 v[28:31], v[116:119], v[156:159], v[28:31]
    ds_read_b64_tr_b16 v[84:85], v10 offset:8
    ds_read_b64_tr_b16 v[86:87], v10 offset:1288
    v_mfma_f32_16x16x32_bf16 v[32:35], v[120:123], v[152:155], v[32:35]
    ds_read_b64_tr_b16 v[88:89], v10 offset:16
    ds_read_b64_tr_b16 v[90:91], v10 offset:1296
    v_mfma_f32_16x16x32_bf16 v[36:39], v[120:123], v[156:159], v[36:39]
    ds_read_b64_tr_b16 v[92:93], v10 offset:24
    ds_read_b64_tr_b16 v[94:95], v10 offset:1304
    v_mfma_f32_16x16x32_bf16 v[40:43], v[124:127], v[152:155], v[40:43]
    ds_read_b64_tr_b16 v[96:97], v10 offset:32
    ds_read_b64_tr_b16 v[98:99], v10 offset:1312
    v_mfma_f32_16x16x32_bf16 v[44:47], v[124:127], v[156:159], v[44:47]
    ds_read_b64_tr_b16 v[100:101], v11 offset:10240
    ds_read_b64_tr_b16 v[102:103], v11 offset:10320
    v_mfma_f32_16x16x32_bf16 v[48:51], v[128:131], v[152:155], v[48:51]
    ds_read_b64_tr_b16 v[104:105], v11 offset:10272
    ds_read_b64_tr_b16 v[106:107], v11 offset:10352
    v_mfma_f32_16x16x32_bf16 v[52:55], v[128:131], v[156:159], v[52:55]
    ds_read_b64_tr_b16 v[108:109], v11 offset:10304
    ds_read_b64_tr_b16 v[110:111], v11 offset:10384
    v_mfma_f32_16x16x32_bf16 v[56:59], v[132:135], v[152:155], v[56:59]
    s_add_u32 m0, s47, 30720
    s_mul_i32 s60, s38, 245760
    buffer_load_dwordx4 v4, s[12:15], s60 offen lds
    v_mfma_f32_16x16x32_bf16 v[60:63], v[132:135], v[156:159], v[60:63]
    s_add_u32 m0, s47, 34816
    s_nop 0
    buffer_load_dwordx4 v5, s[12:15], s60 offen lds
    v_mfma_f32_16x16x32_bf16 v[64:67], v[136:139], v[152:155], v[64:67]
    s_add_u32 m0, s47, 38912
    s_nop 0
    buffer_load_dwordx4 v6, s[12:15], s60 offen lds
    v_mfma_f32_16x16x32_bf16 v[68:71], v[136:139], v[156:159], v[68:71]
    s_add_u32 m0, s48, 30720
    s_mov_b32 exec_hi, 0xffff
    buffer_load_dwordx4 v7, s[12:15], s60 offen lds
    s_mov_b32 exec_hi, -1
    v_mfma_f32_16x16x32_bf16 v[72:75], v[140:143], v[152:155], v[72:75]
    v_mfma_f32_16x16x32_bf16 v[76:79], v[140:143], v[156:159], v[76:79]
    s_waitcnt lgkmcnt(0)
    v_mfma_f32_16x16x32_bf16 v[16:19], v[80:83], v[160:163], v[16:19]
    ds_read_b64_tr_b16 v[112:113], v10 offset:5120
    ds_read_b64_tr_b16 v[114:115], v10 offset:6400
    v_mfma_f32_16x16x32_bf16 v[20:23], v[80:83], v[164:167], v[20:23]
    ds_read_b64_tr_b16 v[116:117], v10 offset:5128
    ds_read_b64_tr_b16 v[118:119], v10 offset:6408
    v_mfma_f32_16x16x32_bf16 v[24:27], v[84:87], v[160:163], v[24:27]
    ds_read_b64_tr_b16 v[120:121], v10 offset:5136
    ds_read_b64_tr_b16 v[122:123], v10 offset:6416
    v_mfma_f32_16x16x32_bf16 v[28:31], v[84:87], v[164:167], v[28:31]
    ds_read_b64_tr_b16 v[124:125], v10 offset:5144
    ds_read_b64_tr_b16 v[126:127], v10 offset:6424
    v_mfma_f32_16x16x32_bf16 v[32:35], v[88:91], v[160:163], v[32:35]
    ds_read_b64_tr_b16 v[128:129], v10 offset:5152
    ds_read_b64_tr_b16 v[130:131], v10 offset:6432
    v_mfma_f32_16x16x32_bf16 v[36:39], v[88:91], v[164:167], v[36:39]
    ds_read_b64_tr_b16 v[132:133], v11 offset:12800
    ds_read_b64_tr_b16 v[134:135], v11 offset:12880
    v_mfma_f32_16x16x32_bf16 v[40:43], v[92:95], v[160:163], v[40:43]
    ds_read_b64_tr_b16 v[136:137], v11 offset:12832
    ds_read_b64_tr_b16 v[138:139], v11 offset:12912
    v_mfma_f32_16x16x32_bf16 v[44:47], v[92:95], v[164:167], v[44:47]
    ds_read_b64_tr_b16 v[140:141], v11 offset:12864
    ds_read_b64_tr_b16 v[142:143], v11 offset:12944
    v_mfma_f32_16x16x32_bf16 v[48:51], v[96:99], v[160:163], v[48:51]
    s_lshl_b32 s51, s38, 7
    s_add_u32 m0, s46, 16384
    s_add_u32 s52, s51, 20480
    buffer_load_dwordx4 v2, s[8:11], s51 offen lds
    v_mfma_f32_16x16x32_bf16 v[52:55], v[96:99], v[164:167], v[52:55]
    s_add_u32 m0, s46, 17408
    s_add_u32 s38, s38, 1
    buffer_load_dwordx4 v3, s[8:11], s51 offen lds
    v_mfma_f32_16x16x32_bf16 v[56:59], v[100:103], v[160:163], v[56:59]
    s_add_u32 m0, s46, 18432
    s_cmp_eq_u32 s38, 10
    buffer_load_dwordx4 v2, s[8:11], s52 offen lds
    s_cselect_b32 s38, 0, s38
    v_mfma_f32_16x16x32_bf16 v[60:63], v[100:103], v[164:167], v[60:63]
    s_add_u32 m0, s46, 19456
    s_nop 0
    buffer_load_dwordx4 v3, s[8:11], s52 offen lds
    v_mfma_f32_16x16x32_bf16 v[64:67], v[104:107], v[160:163], v[64:67]
    ds_read_b64_tr_b16 v[206:207], v246 offset:24
    ds_read_b64_tr_b16 v[208:209], v246 offset:184
    v_mfma_f32_16x16x32_bf16 v[68:71], v[104:107], v[164:167], v[68:71]
    ds_read_b64_tr_b16 v[210:211], v246 offset:344
    ds_read_b64_tr_b16 v[212:213], v246 offset:504
    v_mfma_f32_16x16x32_bf16 v[72:75], v[108:111], v[160:163], v[72:75]
    ds_read_b64_tr_b16 v[214:215], v246 offset:664
    ds_read_b64_tr_b16 v[216:217], v246 offset:32
    v_mfma_f32_16x16x32_bf16 v[76:79], v[108:111], v[164:167], v[76:79]
    ds_read_b64_tr_b16 v[218:219], v246 offset:192
    ds_read_b64_tr_b16 v[220:221], v246 offset:352
    ds_read_b64_tr_b16 v[222:223], v246 offset:512
    ds_read_b64_tr_b16 v[224:225], v246 offset:672
    s_waitcnt lgkmcnt(0)
    s_waitcnt vmcnt(8)
    s_barrier
    v_mfma_f32_16x16x32_bf16 v[16:19], v[112:115], v[168:171], v[16:19]
    ds_read_b128 v[144:147], v8 offset:0
    ds_read_b128 v[148:151], v8 offset:2048
    v_mfma_f32_16x16x32_bf16 v[20:23], v[112:115], v[172:175], v[20:23]
    ds_read_b128 v[152:155], v9 offset:0
    ds_read_b128 v[156:159], v9 offset:2048
    v_mfma_f32_16x16x32_bf16 v[24:27], v[116:119], v[168:171], v[24:27]
    ds_read_b64_tr_b16 v[80:81], v10 offset:15360
    ds_read_b64_tr_b16 v[82:83], v10 offset:16640
    v_mfma_f32_16x16x32_bf16 v[28:31], v[116:119], v[172:175], v[28:31]
    ds_read_b64_tr_b16 v[84:85], v10 offset:15368
    ds_read_b64_tr_b16 v[86:87], v10 offset:16648
    v_mfma_f32_16x16x32_bf16 v[32:35], v[120:123], v[168:171], v[32:35]
    ds_read_b64_tr_b16 v[88:89], v10 offset:15376
    ds_read_b64_tr_b16 v[90:91], v10 offset:16656
    v_mfma_f32_16x16x32_bf16 v[36:39], v[120:123], v[172:175], v[36:39]
    ds_read_b64_tr_b16 v[92:93], v10 offset:15384
    ds_read_b64_tr_b16 v[94:95], v10 offset:16664
    v_mfma_f32_16x16x32_bf16 v[40:43], v[124:127], v[168:171], v[40:43]
    ds_read_b64_tr_b16 v[96:97], v10 offset:15392
    ds_read_b64_tr_b16 v[98:99], v10 offset:16672
    v_mfma_f32_16x16x32_bf16 v[44:47], v[124:127], v[172:175], v[44:47]
    ds_read_b64_tr_b16 v[100:101], v11 offset:25600
    ds_read_b64_tr_b16 v[102:103], v11 offset:25680
    v_mfma_f32_16x16x32_bf16 v[48:51], v[128:131], v[168:171], v[48:51]
    ds_read_b64_tr_b16 v[104:105], v11 offset:25632
    ds_read_b64_tr_b16 v[106:107], v11 offset:25712
    v_mfma_f32_16x16x32_bf16 v[52:55], v[128:131], v[172:175], v[52:55]
    ds_read_b64_tr_b16 v[108:109], v11 offset:25664
    ds_read_b64_tr_b16 v[110:111], v11 offset:25744
    v_mfma_f32_16x16x32_bf16 v[56:59], v[132:135], v[168:171], v[56:59]
    s_add_u32 m0, s47, 0
    s_mul_i32 s60, s38, 245760
    buffer_load_dwordx4 v4, s[12:15], s60 offen lds
    v_mfma_f32_16x16x32_bf16 v[60:63], v[132:135], v[172:175], v[60:63]
    s_add_u32 m0, s47, 4096
    s_nop 0
    buffer_load_dwordx4 v5, s[12:15], s60 offen lds
    v_mfma_f32_16x16x32_bf16 v[64:67], v[136:139], v[168:171], v[64:67]
    s_add_u32 m0, s47, 8192
    s_nop 0
    buffer_load_dwordx4 v6, s[12:15], s60 offen lds
    v_mfma_f32_16x16x32_bf16 v[68:71], v[136:139], v[172:175], v[68:71]
    s_add_u32 m0, s48, 0
    s_mov_b32 exec_hi, 0xffff
    buffer_load_dwordx4 v7, s[12:15], s60 offen lds
    s_mov_b32 exec_hi, -1
    v_mfma_f32_16x16x32_bf16 v[72:75], v[140:143], v[168:171], v[72:75]
    v_mfma_f32_16x16x32_bf16 v[76:79], v[140:143], v[172:175], v[76:79]
    s_waitcnt lgkmcnt(0)
    v_mfma_f32_16x16x32_bf16 v[16:19], v[80:83], v[144:147], v[16:19]
    ds_read_b64_tr_b16 v[112:113], v10 offset:20480
    ds_read_b64_tr_b16 v[114:115], v10 offset:21760
    v_mfma_f32_16x16x32_bf16 v[20:23], v[80:83], v[148:151], v[20:23]
    ds_read_b64_tr_b16 v[116:117], v10 offset:20488
    ds_read_b64_tr_b16 v[118:119], v10 offset:21768
    v_mfma_f32_16x16x32_bf16 v[24:27], v[84:87], v[144:147], v[24:27]
    ds_read_b64_tr_b16 v[120:121], v10 offset:20496
    ds_read_b64_tr_b16 v[122:123], v10 offset:21776
    v_mfma_f32_16x16x32_bf16 v[28:31], v[84:87], v[148:151], v[28:31]
    ds_read_b64_tr_b16 v[124:125], v10 offset:20504
    ds_read_b64_tr_b16 v[126:127], v10 offset:21784
    v_mfma_f32_16x16x32_bf16 v[32:35], v[88:91], v[144:147], v[32:35]
    ds_read_b64_tr_b16 v[128:129], v10 offset:20512
    ds_read_b64_tr_b16 v[130:131], v10 offset:21792
    v_mfma_f32_16x16x32_bf16 v[36:39], v[88:91], v[148:151], v[36:39]
    ds_read_b64_tr_b16 v[132:133], v11 offset:28160
    ds_read_b64_tr_b16 v[134:135], v11 offset:28240
    v_mfma_f32_16x16x32_bf16 v[40:43], v[92:95], v[144:147], v[40:43]
    ds_read_b64_tr_b16 v[136:137], v11 offset:28192
    ds_read_b64_tr_b16 v[138:139], v11 offset:28272
    v_mfma_f32_16x16x32_bf16 v[44:47], v[92:95], v[148:151], v[44:47]
    ds_read_b64_tr_b16 v[140:141], v11 offset:28224
    ds_read_b64_tr_b16 v[142:143], v11 offset:28304
    v_mfma_f32_16x16x32_bf16 v[48:51], v[96:99], v[144:147], v[48:51]
    s_lshl_b32 s51, s38, 7
    s_add_u32 m0, s46, 0
    s_add_u32 s52, s51, 20480
    buffer_load_dwordx4 v2, s[8:11], s51 offen lds
    v_mfma_f32_16x16x32_bf16 v[52:55], v[96:99], v[148:151], v[52:55]
    s_add_u32 m0, s46, 1024
    s_add_u32 s38, s38, 1
    buffer_load_dwordx4 v3, s[8:11], s51 offen lds
    v_mfma_f32_16x16x32_bf16 v[56:59], v[100:103], v[144:147], v[56:59]
    s_add_u32 m0, s46, 2048
    s_cmp_eq_u32 s38, 10
    buffer_load_dwordx4 v2, s[8:11], s52 offen lds
    s_cselect_b32 s38, 0, s38
    v_mfma_f32_16x16x32_bf16 v[60:63], v[100:103], v[148:151], v[60:63]
    s_add_u32 m0, s46, 3072
    s_nop 0
    buffer_load_dwordx4 v3, s[8:11], s52 offen lds
    v_mfma_f32_16x16x32_bf16 v[64:67], v[104:107], v[144:147], v[64:67]
    v_mfma_f32_16x16x32_bf16 v[68:71], v[104:107], v[148:151], v[68:71]
    v_mfma_f32_16x16x32_bf16 v[72:75], v[108:111], v[144:147], v[72:75]
    v_mfma_f32_16x16x32_bf16 v[76:79], v[108:111], v[148:151], v[76:79]
    s_waitcnt lgkmcnt(0)
    s_waitcnt vmcnt(8)
    s_barrier
    s_and_b32 s40, s39, 1
    s_mul_i32 s41, s40, 960
    s_add_u32 m0, s41, 78848
    s_xor_b32 s42, s36, 1
    s_lshl_b32 s42, s42, 1
    s_add_u32 s42, s42, s40
    s_mul_i32 s42, s42, 800
    s_mov_b32 exec_hi, 0x3ffff
    buffer_load_dwordx4 v238, s[28:31], s42 offen lds
    s_mov_b64 exec, -1
    v_mfma_f32_16x16x32_bf16 v[16:19], v[112:115], v[152:155], v[16:19]
    ds_read_b128 v[160:163], v8 offset:16384
    ds_read_b128 v[164:167], v8 offset:18432
    v_mfma_f32_16x16x32_bf16 v[20:23], v[112:115], v[156:159], v[20:23]
    ds_read_b128 v[168:171], v9 offset:16384
    ds_read_b128 v[172:175], v9 offset:18432
    v_mfma_f32_16x16x32_bf16 v[24:27], v[116:119], v[152:155], v[24:27]
    ds_read_b64_tr_b16 v[80:81], v10 offset:30720
    ds_read_b64_tr_b16 v[82:83], v10 offset:32000
    v_mfma_f32_16x16x32_bf16 v[28:31], v[116:119], v[156:159], v[28:31]
    ds_read_b64_tr_b16 v[84:85], v10 offset:30728
    ds_read_b64_tr_b16 v[86:87], v10 offset:32008
    v_mfma_f32_16x16x32_bf16 v[32:35], v[120:123], v[152:155], v[32:35]
    ds_read_b64_tr_b16 v[88:89], v10 offset:30736
    ds_read_b64_tr_b16 v[90:91], v10 offset:32016
    v_mfma_f32_16x16x32_bf16 v[36:39], v[120:123], v[156:159], v[36:39]
    ds_read_b64_tr_b16 v[92:93], v10 offset:30744
    ds_read_b64_tr_b16 v[94:95], v10 offset:32024
    v_mfma_f32_16x16x32_bf16 v[40:43], v[124:127], v[152:155], v[40:43]
    ds_read_b64_tr_b16 v[96:97], v10 offset:30752
    ds_read_b64_tr_b16 v[98:99], v10 offset:32032
    v_mfma_f32_16x16x32_bf16 v[44:47], v[124:127], v[156:159], v[44:47]
    ds_read_b64_tr_b16 v[100:101], v11 offset:40960
    ds_read_b64_tr_b16 v[102:103], v11 offset:41040
    v_mfma_f32_16x16x32_bf16 v[48:51], v[128:131], v[152:155], v[48:51]
    ds_read_b64_tr_b16 v[104:105], v11 offset:40992
    ds_read_b64_tr_b16 v[106:107], v11 offset:41072
    v_mfma_f32_16x16x32_bf16 v[52:55], v[128:131], v[156:159], v[52:55]
    ds_read_b64_tr_b16 v[108:109], v11 offset:41024
    ds_read_b64_tr_b16 v[110:111], v11 offset:41104
    v_mfma_f32_16x16x32_bf16 v[56:59], v[132:135], v[152:155], v[56:59]
    s_add_u32 m0, s47, 15360
    s_mul_i32 s60, s38, 245760
    buffer_load_dwordx4 v4, s[12:15], s60 offen lds
    v_mfma_f32_16x16x32_bf16 v[60:63], v[132:135], v[156:159], v[60:63]
    s_add_u32 m0, s47, 19456
    s_nop 0
    buffer_load_dwordx4 v5, s[12:15], s60 offen lds
    v_mfma_f32_16x16x32_bf16 v[64:67], v[136:139], v[152:155], v[64:67]
    s_add_u32 m0, s47, 23552
    s_nop 0
    buffer_load_dwordx4 v6, s[12:15], s60 offen lds
    v_mfma_f32_16x16x32_bf16 v[68:71], v[136:139], v[156:159], v[68:71]
    s_add_u32 m0, s48, 15360
    s_mov_b32 exec_hi, 0xffff
    buffer_load_dwordx4 v7, s[12:15], s60 offen lds
    s_mov_b32 exec_hi, -1
    v_mfma_f32_16x16x32_bf16 v[72:75], v[140:143], v[152:155], v[72:75]
    v_mfma_f32_16x16x32_bf16 v[76:79], v[140:143], v[156:159], v[76:79]
    s_waitcnt lgkmcnt(0)
    v_mfma_f32_16x16x32_bf16 v[16:19], v[80:83], v[160:163], v[16:19]
    ds_read_b64_tr_b16 v[112:113], v10 offset:35840
    ds_read_b64_tr_b16 v[114:115], v10 offset:37120
    v_mfma_f32_16x16x32_bf16 v[20:23], v[80:83], v[164:167], v[20:23]
    ds_read_b64_tr_b16 v[116:117], v10 offset:35848
    ds_read_b64_tr_b16 v[118:119], v10 offset:37128
    v_mfma_f32_16x16x32_bf16 v[24:27], v[84:87], v[160:163], v[24:27]
    ds_read_b64_tr_b16 v[120:121], v10 offset:35856
    ds_read_b64_tr_b16 v[122:123], v10 offset:37136
    v_mfma_f32_16x16x32_bf16 v[28:31], v[84:87], v[164:167], v[28:31]
    ds_read_b64_tr_b16 v[124:125], v10 offset:35864
    ds_read_b64_tr_b16 v[126:127], v10 offset:37144
    v_mfma_f32_16x16x32_bf16 v[32:35], v[88:91], v[160:163], v[32:35]
    ds_read_b64_tr_b16 v[128:129], v10 offset:35872
    ds_read_b64_tr_b16 v[130:131], v10 offset:37152
    v_mfma_f32_16x16x32_bf16 v[36:39], v[88:91], v[164:167], v[36:39]
    ds_read_b64_tr_b16 v[132:133], v11 offset:43520
    ds_read_b64_tr_b16 v[134:135], v11 offset:43600
    v_mfma_f32_16x16x32_bf16 v[40:43], v[92:95], v[160:163], v[40:43]
    ds_read_b64_tr_b16 v[136:137], v11 offset:43552
    ds_read_b64_tr_b16 v[138:139], v11 offset:43632
    v_mfma_f32_16x16x32_bf16 v[44:47], v[92:95], v[164:167], v[44:47]
    ds_read_b64_tr_b16 v[140:141], v11 offset:43584
    ds_read_b64_tr_b16 v[142:143], v11 offset:43664
    v_mfma_f32_16x16x32_bf16 v[48:51], v[96:99], v[160:163], v[48:51]
    s_lshl_b32 s51, s38, 7
    s_add_u32 m0, s46, 16384
    s_add_u32 s52, s51, 20480
    buffer_load_dwordx4 v2, s[8:11], s51 offen lds
    v_mfma_f32_16x16x32_bf16 v[52:55], v[96:99], v[164:167], v[52:55]
    s_add_u32 m0, s46, 17408
    s_add_u32 s38, s38, 1
    buffer_load_dwordx4 v3, s[8:11], s51 offen lds
    v_mfma_f32_16x16x32_bf16 v[56:59], v[100:103], v[160:163], v[56:59]
    s_add_u32 m0, s46, 18432
    s_cmp_eq_u32 s38, 10
    buffer_load_dwordx4 v2, s[8:11], s52 offen lds
    s_cselect_b32 s38, 0, s38
    v_mfma_f32_16x16x32_bf16 v[60:63], v[100:103], v[164:167], v[60:63]
    s_add_u32 m0, s46, 19456
    s_nop 0
    buffer_load_dwordx4 v3, s[8:11], s52 offen lds
    v_mfma_f32_16x16x32_bf16 v[64:67], v[104:107], v[160:163], v[64:67]
    v_mfma_f32_16x16x32_bf16 v[68:71], v[104:107], v[164:167], v[68:71]
    v_mfma_f32_16x16x32_bf16 v[72:75], v[108:111], v[160:163], v[72:75]
    v_mfma_f32_16x16x32_bf16 v[76:79], v[108:111], v[164:167], v[76:79]
    s_waitcnt lgkmcnt(0)
    s_waitcnt vmcnt(8)
    s_barrier
    v_mfma_f32_16x16x32_bf16 v[16:19], v[112:115], v[168:171], v[16:19]
    ds_read_b128 v[144:147], v8 offset:0
    ds_read_b128 v[148:151], v8 offset:2048
    v_mfma_f32_16x16x32_bf16 v[20:23], v[112:115], v[172:175], v[20:23]
    ds_read_b128 v[152:155], v9 offset:0
    ds_read_b128 v[156:159], v9 offset:2048
    v_mfma_f32_16x16x32_bf16 v[24:27], v[116:119], v[168:171], v[24:27]
    ds_read_b64_tr_b16 v[80:81], v10 offset:0
    ds_read_b64_tr_b16 v[82:83], v10 offset:1280
    v_mfma_f32_16x16x32_bf16 v[28:31], v[116:119], v[172:175], v[28:31]
    ds_read_b64_tr_b16 v[84:85], v10 offset:8
    ds_read_b64_tr_b16 v[86:87], v10 offset:1288
    v_mfma_f32_16x16x32_bf16 v[32:35], v[120:123], v[168:171], v[32:35]
    ds_read_b64_tr_b16 v[88:89], v10 offset:16
    ds_read_b64_tr_b16 v[90:91], v10 offset:1296
    v_mfma_f32_16x16x32_bf16 v[36:39], v[120:123], v[172:175], v[36:39]
    ds_read_b64_tr_b16 v[92:93], v10 offset:24
    ds_read_b64_tr_b16 v[94:95], v10 offset:1304
    v_mfma_f32_16x16x32_bf16 v[40:43], v[124:127], v[168:171], v[40:43]
    ds_read_b64_tr_b16 v[96:97], v10 offset:32
    ds_read_b64_tr_b16 v[98:99], v10 offset:1312
    v_mfma_f32_16x16x32_bf16 v[44:47], v[124:127], v[172:175], v[44:47]
    ds_read_b64_tr_b16 v[100:101], v11 offset:10240
    ds_read_b64_tr_b16 v[102:103], v11 offset:10320
    v_mfma_f32_16x16x32_bf16 v[48:51], v[128:131], v[168:171], v[48:51]
    ds_read_b64_tr_b16 v[104:105], v11 offset:10272
    ds_read_b64_tr_b16 v[106:107], v11 offset:10352
    v_mfma_f32_16x16x32_bf16 v[52:55], v[128:131], v[172:175], v[52:55]
    ds_read_b64_tr_b16 v[108:109], v11 offset:10304
    ds_read_b64_tr_b16 v[110:111], v11 offset:10384
    v_mfma_f32_16x16x32_bf16 v[56:59], v[132:135], v[168:171], v[56:59]
    s_add_u32 m0, s47, 30720
    s_mul_i32 s60, s38, 245760
    buffer_load_dwordx4 v4, s[12:15], s60 offen lds
    v_mfma_f32_16x16x32_bf16 v[60:63], v[132:135], v[172:175], v[60:63]
    s_add_u32 m0, s47, 34816
    s_nop 0
    buffer_load_dwordx4 v5, s[12:15], s60 offen lds
    v_mfma_f32_16x16x32_bf16 v[64:67], v[136:139], v[168:171], v[64:67]
    s_add_u32 m0, s47, 38912
    s_nop 0
    buffer_load_dwordx4 v6, s[12:15], s60 offen lds
    v_mfma_f32_16x16x32_bf16 v[68:71], v[136:139], v[172:175], v[68:71]
    s_add_u32 m0, s48, 30720
    s_mov_b32 exec_hi, 0xffff
    buffer_load_dwordx4 v7, s[12:15], s60 offen lds
    s_mov_b32 exec_hi, -1
    v_mfma_f32_16x16x32_bf16 v[72:75], v[140:143], v[168:171], v[72:75]
    v_mfma_f32_16x16x32_bf16 v[76:79], v[140:143], v[172:175], v[76:79]
    s_waitcnt lgkmcnt(0)
    v_mfma_f32_16x16x32_bf16 v[16:19], v[80:83], v[144:147], v[16:19]
    ds_read_b64_tr_b16 v[112:113], v10 offset:5120
    ds_read_b64_tr_b16 v[114:115], v10 offset:6400
    v_mfma_f32_16x16x32_bf16 v[20:23], v[80:83], v[148:151], v[20:23]
    ds_read_b64_tr_b16 v[116:117], v10 offset:5128
    ds_read_b64_tr_b16 v[118:119], v10 offset:6408
    v_mfma_f32_16x16x32_bf16 v[24:27], v[84:87], v[144:147], v[24:27]
    ds_read_b64_tr_b16 v[120:121], v10 offset:5136
    ds_read_b64_tr_b16 v[122:123], v10 offset:6416
    v_mfma_f32_16x16x32_bf16 v[28:31], v[84:87], v[148:151], v[28:31]
    ds_read_b64_tr_b16 v[124:125], v10 offset:5144
    ds_read_b64_tr_b16 v[126:127], v10 offset:6424
    v_mfma_f32_16x16x32_bf16 v[32:35], v[88:91], v[144:147], v[32:35]
    ds_read_b64_tr_b16 v[128:129], v10 offset:5152
    ds_read_b64_tr_b16 v[130:131], v10 offset:6432
    v_mfma_f32_16x16x32_bf16 v[36:39], v[88:91], v[148:151], v[36:39]
    ds_read_b64_tr_b16 v[132:133], v11 offset:12800
    ds_read_b64_tr_b16 v[134:135], v11 offset:12880
    v_mfma_f32_16x16x32_bf16 v[40:43], v[92:95], v[144:147], v[40:43]
    ds_read_b64_tr_b16 v[136:137], v11 offset:12832
    ds_read_b64_tr_b16 v[138:139], v11 offset:12912
    v_mfma_f32_16x16x32_bf16 v[44:47], v[92:95], v[148:151], v[44:47]
    ds_read_b64_tr_b16 v[140:141], v11 offset:12864
    ds_read_b64_tr_b16 v[142:143], v11 offset:12944
    v_mfma_f32_16x16x32_bf16 v[48:51], v[96:99], v[144:147], v[48:51]
    s_lshl_b32 s51, s38, 7
    s_add_u32 m0, s46, 0
    s_add_u32 s52, s51, 20480
    buffer_load_dwordx4 v2, s[8:11], s51 offen lds
    v_mfma_f32_16x16x32_bf16 v[52:55], v[96:99], v[148:151], v[52:55]
    s_add_u32 m0, s46, 1024
    s_add_u32 s38, s38, 1
    buffer_load_dwordx4 v3, s[8:11], s51 offen lds
    v_mfma_f32_16x16x32_bf16 v[56:59], v[100:103], v[144:147], v[56:59]
    s_add_u32 m0, s46, 2048
    s_cmp_eq_u32 s38, 10
    buffer_load_dwordx4 v2, s[8:11], s52 offen lds
    s_cselect_b32 s38, 0, s38
    v_mfma_f32_16x16x32_bf16 v[60:63], v[100:103], v[148:151], v[60:63]
    s_add_u32 m0, s46, 3072
    s_nop 0
    buffer_load_dwordx4 v3, s[8:11], s52 offen lds
    v_mfma_f32_16x16x32_bf16 v[64:67], v[104:107], v[144:147], v[64:67]
    v_mfma_f32_16x16x32_bf16 v[68:71], v[104:107], v[148:151], v[68:71]
    v_mfma_f32_16x16x32_bf16 v[72:75], v[108:111], v[144:147], v[72:75]
    v_mfma_f32_16x16x32_bf16 v[76:79], v[108:111], v[148:151], v[76:79]
    s_waitcnt lgkmcnt(0)
    s_waitcnt vmcnt(8)
    s_barrier
    v_mfma_f32_16x16x32_bf16 v[16:19], v[112:115], v[152:155], v[16:19]
    ds_read_b128 v[160:163], v8 offset:16384
    ds_read_b128 v[164:167], v8 offset:18432
    v_mfma_f32_16x16x32_bf16 v[20:23], v[112:115], v[156:159], v[20:23]
    ds_read_b128 v[168:171], v9 offset:16384
    ds_read_b128 v[172:175], v9 offset:18432
    v_mfma_f32_16x16x32_bf16 v[24:27], v[116:119], v[152:155], v[24:27]
    ds_read_b64_tr_b16 v[80:81], v10 offset:15360
    ds_read_b64_tr_b16 v[82:83], v10 offset:16640
    v_mfma_f32_16x16x32_bf16 v[28:31], v[116:119], v[156:159], v[28:31]
    ds_read_b64_tr_b16 v[84:85], v10 offset:15368
    ds_read_b64_tr_b16 v[86:87], v10 offset:16648
    v_mfma_f32_16x16x32_bf16 v[32:35], v[120:123], v[152:155], v[32:35]
    ds_read_b64_tr_b16 v[88:89], v10 offset:15376
    ds_read_b64_tr_b16 v[90:91], v10 offset:16656
    v_mfma_f32_16x16x32_bf16 v[36:39], v[120:123], v[156:159], v[36:39]
    ds_read_b64_tr_b16 v[92:93], v10 offset:15384
    ds_read_b64_tr_b16 v[94:95], v10 offset:16664
    v_mfma_f32_16x16x32_bf16 v[40:43], v[124:127], v[152:155], v[40:43]
    ds_read_b64_tr_b16 v[96:97], v10 offset:15392
    ds_read_b64_tr_b16 v[98:99], v10 offset:16672
    v_mfma_f32_16x16x32_bf16 v[44:47], v[124:127], v[156:159], v[44:47]
    ds_read_b64_tr_b16 v[100:101], v11 offset:25600
    ds_read_b64_tr_b16 v[102:103], v11 offset:25680
    v_mfma_f32_16x16x32_bf16 v[48:51], v[128:131], v[152:155], v[48:51]
    ds_read_b64_tr_b16 v[104:105], v11 offset:25632
    ds_read_b64_tr_b16 v[106:107], v11 offset:25712
    v_mfma_f32_16x16x32_bf16 v[52:55], v[128:131], v[156:159], v[52:55]
    ds_read_b64_tr_b16 v[108:109], v11 offset:25664
    ds_read_b64_tr_b16 v[110:111], v11 offset:25744
    v_mfma_f32_16x16x32_bf16 v[56:59], v[132:135], v[152:155], v[56:59]
    s_add_u32 m0, s47, 0
    s_mul_i32 s60, s38, 245760
    buffer_load_dwordx4 v4, s[12:15], s60 offen lds
    v_mfma_f32_16x16x32_bf16 v[60:63], v[132:135], v[156:159], v[60:63]
    s_add_u32 m0, s47, 4096
    s_nop 0
    buffer_load_dwordx4 v5, s[12:15], s60 offen lds
    v_mfma_f32_16x16x32_bf16 v[64:67], v[136:139], v[152:155], v[64:67]
    s_add_u32 m0, s47, 8192
    s_nop 0
    buffer_load_dwordx4 v6, s[12:15], s60 offen lds
    v_mfma_f32_16x16x32_bf16 v[68:71], v[136:139], v[156:159], v[68:71]
    s_add_u32 m0, s48, 0
    s_mov_b32 exec_hi, 0xffff
    buffer_load_dwordx4 v7, s[12:15], s60 offen lds
    s_mov_b32 exec_hi, -1
    v_mfma_f32_16x16x32_bf16 v[72:75], v[140:143], v[152:155], v[72:75]
    v_mfma_f32_16x16x32_bf16 v[76:79], v[140:143], v[156:159], v[76:79]
    s_waitcnt lgkmcnt(0)
    v_mfma_f32_16x16x32_bf16 v[16:19], v[80:83], v[160:163], v[16:19]
    ds_read_b64_tr_b16 v[112:113], v10 offset:20480
    ds_read_b64_tr_b16 v[114:115], v10 offset:21760
    v_mfma_f32_16x16x32_bf16 v[20:23], v[80:83], v[164:167], v[20:23]
    ds_read_b64_tr_b16 v[116:117], v10 offset:20488
    ds_read_b64_tr_b16 v[118:119], v10 offset:21768
    v_mfma_f32_16x16x32_bf16 v[24:27], v[84:87], v[160:163], v[24:27]
    ds_read_b64_tr_b16 v[120:121], v10 offset:20496
    ds_read_b64_tr_b16 v[122:123], v10 offset:21776
    v_mfma_f32_16x16x32_bf16 v[28:31], v[84:87], v[164:167], v[28:31]
    ds_read_b64_tr_b16 v[124:125], v10 offset:20504
    ds_read_b64_tr_b16 v[126:127], v10 offset:21784
    v_mfma_f32_16x16x32_bf16 v[32:35], v[88:91], v[160:163], v[32:35]
    ds_read_b64_tr_b16 v[128:129], v10 offset:20512
    ds_read_b64_tr_b16 v[130:131], v10 offset:21792
    v_mfma_f32_16x16x32_bf16 v[36:39], v[88:91], v[164:167], v[36:39]
    ds_read_b64_tr_b16 v[132:133], v11 offset:28160
    ds_read_b64_tr_b16 v[134:135], v11 offset:28240
    v_mfma_f32_16x16x32_bf16 v[40:43], v[92:95], v[160:163], v[40:43]
    ds_read_b64_tr_b16 v[136:137], v11 offset:28192
    ds_read_b64_tr_b16 v[138:139], v11 offset:28272
    v_mfma_f32_16x16x32_bf16 v[44:47], v[92:95], v[164:167], v[44:47]
    ds_read_b64_tr_b16 v[140:141], v11 offset:28224
    ds_read_b64_tr_b16 v[142:143], v11 offset:28304
    v_mfma_f32_16x16x32_bf16 v[48:51], v[96:99], v[160:163], v[48:51]
    s_lshl_b32 s51, s38, 7
    s_add_u32 m0, s46, 16384
    s_add_u32 s52, s51, 20480
    buffer_load_dwordx4 v2, s[8:11], s51 offen lds
    v_mfma_f32_16x16x32_bf16 v[52:55], v[96:99], v[164:167], v[52:55]
    s_add_u32 m0, s46, 17408
    s_add_u32 s38, s38, 1
    buffer_load_dwordx4 v3, s[8:11], s51 offen lds
    v_mfma_f32_16x16x32_bf16 v[56:59], v[100:103], v[160:163], v[56:59]
    s_add_u32 m0, s46, 18432
    s_cmp_eq_u32 s38, 10
    buffer_load_dwordx4 v2, s[8:11], s52 offen lds
    s_cselect_b32 s38, 0, s38
    v_mfma_f32_16x16x32_bf16 v[60:63], v[100:103], v[164:167], v[60:63]
    s_add_u32 m0, s46, 19456
    s_nop 0
    buffer_load_dwordx4 v3, s[8:11], s52 offen lds
    v_mfma_f32_16x16x32_bf16 v[64:67], v[104:107], v[160:163], v[64:67]
    v_mfma_f32_16x16x32_bf16 v[68:71], v[104:107], v[164:167], v[68:71]
    v_mfma_f32_16x16x32_bf16 v[72:75], v[108:111], v[160:163], v[72:75]
    v_mfma_f32_16x16x32_bf16 v[76:79], v[108:111], v[164:167], v[76:79]
    s_waitcnt lgkmcnt(0)
    s_waitcnt vmcnt(8)
    s_barrier
    s_add_u32 s40, s59, s58
    s_add_u32 s28, s40, 0
    s_and_b32 s28, s28, 3
    s_add_u32 s29, s40, 1
    s_and_b32 s29, s29, 3
    s_add_u32 s30, s40, 2
    s_and_b32 s30, s30, 3
    s_add_u32 s31, s40, 3
    s_and_b32 s31, s31, 3
    v_mfma_f32_16x16x32_bf16 v[16:19], v[112:115], v[168:171], v[16:19]
    ds_read_b128 v[144:147], v8 offset:0
    ds_read_b128 v[148:151], v8 offset:2048
    v_mfma_f32_16x16x32_bf16 v[20:23], v[112:115], v[172:175], v[20:23]
    ds_read_b128 v[152:155], v9 offset:0
    ds_read_b128 v[156:159], v9 offset:2048
    v_mfma_f32_16x16x32_bf16 v[24:27], v[116:119], v[168:171], v[24:27]
    ds_read_b64_tr_b16 v[80:81], v10 offset:30720
    ds_read_b64_tr_b16 v[82:83], v10 offset:32000
    v_mfma_f32_16x16x32_bf16 v[28:31], v[116:119], v[172:175], v[28:31]
    ds_read_b64_tr_b16 v[84:85], v10 offset:30728
    ds_read_b64_tr_b16 v[86:87], v10 offset:32008
    v_mfma_f32_16x16x32_bf16 v[32:35], v[120:123], v[168:171], v[32:35]
    ds_read_b64_tr_b16 v[88:89], v10 offset:30736
    ds_read_b64_tr_b16 v[90:91], v10 offset:32016
    v_mfma_f32_16x16x32_bf16 v[36:39], v[120:123], v[172:175], v[36:39]
    ds_read_b64_tr_b16 v[92:93], v10 offset:30744
    ds_read_b64_tr_b16 v[94:95], v10 offset:32024
    v_mfma_f32_16x16x32_bf16 v[40:43], v[124:127], v[168:171], v[40:43]
    ds_read_b64_tr_b16 v[96:97], v10 offset:30752
    ds_read_b64_tr_b16 v[98:99], v10 offset:32032
    v_mfma_f32_16x16x32_bf16 v[44:47], v[124:127], v[172:175], v[44:47]
    ds_read_b64_tr_b16 v[100:101], v11 offset:40960
    ds_read_b64_tr_b16 v[102:103], v11 offset:41040
    v_mfma_f32_16x16x32_bf16 v[48:51], v[128:131], v[168:171], v[48:51]
    ds_read_b64_tr_b16 v[104:105], v11 offset:40992
    ds_read_b64_tr_b16 v[106:107], v11 offset:41072
    v_mfma_f32_16x16x32_bf16 v[52:55], v[128:131], v[172:175], v[52:55]
    ds_read_b64_tr_b16 v[108:109], v11 offset:41024
    ds_read_b64_tr_b16 v[110:111], v11 offset:41104
    v_mfma_f32_16x16x32_bf16 v[56:59], v[132:135], v[168:171], v[56:59]
    v_mfma_f32_16x16x32_bf16 v[60:63], v[132:135], v[172:175], v[60:63]
    v_mfma_f32_16x16x32_bf16 v[64:67], v[136:139], v[168:171], v[64:67]
    v_mfma_f32_16x16x32_bf16 v[68:71], v[136:139], v[172:175], v[68:71]
    v_mfma_f32_16x16x32_bf16 v[72:75], v[140:143], v[168:171], v[72:75]
    v_mfma_f32_16x16x32_bf16 v[76:79], v[140:143], v[172:175], v[76:79]
    s_waitcnt lgkmcnt(0)
    v_mfma_f32_16x16x32_bf16 v[16:19], v[80:83], v[144:147], v[16:19]
    s_add_u32 s44, s33, 20480
    v_mov_b32 v252, -1
    v_mov_b32 v253, -1
    v_mov_b32 v254, -1
    v_mov_b32 v255, -1
    buffer_store_dwordx4 v[252:255], v235, s[16:19], s32 offen sc1
    ds_read_b64_tr_b16 v[112:113], v10 offset:35840
    ds_read_b64_tr_b16 v[114:115], v10 offset:37120
    v_mfma_f32_16x16x32_bf16 v[20:23], v[80:83], v[148:151], v[20:23]
    ds_read_b64_tr_b16 v[116:117], v10 offset:35848
    ds_read_b64_tr_b16 v[118:119], v10 offset:37128
    v_mfma_f32_16x16x32_bf16 v[24:27], v[84:87], v[144:147], v[24:27]
    buffer_store_dwordx4 v[252:255], v238, s[16:19], s33 offen sc1
    ds_read_b64_tr_b16 v[120:121], v10 offset:35856
    ds_read_b64_tr_b16 v[122:123], v10 offset:37136
    v_mfma_f32_16x16x32_bf16 v[28:31], v[84:87], v[148:151], v[28:31]
    ds_read_b64_tr_b16 v[124:125], v10 offset:35864
    ds_read_b64_tr_b16 v[126:127], v10 offset:37144
    v_mfma_f32_16x16x32_bf16 v[32:35], v[88:91], v[144:147], v[32:35]
    buffer_store_dwordx4 v[252:255], v238, s[16:19], s44 offen sc1
    ds_read_b64_tr_b16 v[128:129], v10 offset:35872
    ds_read_b64_tr_b16 v[130:131], v10 offset:37152
    v_mfma_f32_16x16x32_bf16 v[36:39], v[88:91], v[148:151], v[36:39]
    ds_read_b64_tr_b16 v[132:133], v11 offset:43520
    ds_read_b64_tr_b16 v[134:135], v11 offset:43600
    v_mfma_f32_16x16x32_bf16 v[40:43], v[92:95], v[144:147], v[40:43]
    buffer_store_dwordx4 v[252:255], v239, s[16:19], s34 offen sc1
    ds_read_b64_tr_b16 v[136:137], v11 offset:43552
    ds_read_b64_tr_b16 v[138:139], v11 offset:43632
    v_mfma_f32_16x16x32_bf16 v[44:47], v[92:95], v[148:151], v[44:47]
    ds_read_b64_tr_b16 v[140:141], v11 offset:43584
    ds_read_b64_tr_b16 v[142:143], v11 offset:43664
    v_mfma_f32_16x16x32_bf16 v[48:51], v[96:99], v[144:147], v[48:51]
    s_lshl_b32 s38, s37, 2
    s_add_u32 s38, s38, s39
    s_lshl_b32 s38, s38, 4
    s_add_u32 s38, s38, s36
    s_lshl_b32 s38, s38, 7
    s_add_u32 s38, s38, 8060928
    s_mov_b64 exec, 0xff
    buffer_store_dwordx4 v[252:255], v238, s[16:19], s35 offen sc1
    buffer_store_dwordx4 v[252:255], v238, s[16:19], s38 offen sc1
    s_mov_b64 exec, -1
    v_mfma_f32_16x16x32_bf16 v[52:55], v[96:99], v[148:151], v[52:55]
    v_mfma_f32_16x16x32_bf16 v[56:59], v[100:103], v[144:147], v[56:59]
    v_mfma_f32_16x16x32_bf16 v[60:63], v[100:103], v[148:151], v[60:63]
    v_mfma_f32_16x16x32_bf16 v[64:67], v[104:107], v[144:147], v[64:67]
    v_mfma_f32_16x16x32_bf16 v[68:71], v[104:107], v[148:151], v[68:71]
    v_mfma_f32_16x16x32_bf16 v[72:75], v[108:111], v[144:147], v[72:75]
    v_mfma_f32_16x16x32_bf16 v[76:79], v[108:111], v[148:151], v[76:79]
    s_waitcnt lgkmcnt(0)
    s_waitcnt vmcnt(6)
    s_barrier
    buffer_store_dword v247, v245, s[16:19], s49 offen sc1
    buffer_store_dword v248, v245, s[16:19], s49 offen offset:4 sc1
    v_mfma_f32_16x16x32_bf16 v[16:19], v[112:115], v[152:155], v[16:19]
    ds_read_b128 v[160:163], v8 offset:16384
    ds_read_b128 v[164:167], v8 offset:18432
    v_mfma_f32_16x16x32_bf16 v[20:23], v[112:115], v[156:159], v[20:23]
    ds_read_b128 v[168:171], v9 offset:16384
    ds_read_b128 v[172:175], v9 offset:18432
    v_mfma_f32_16x16x32_bf16 v[24:27], v[116:119], v[152:155], v[24:27]
    ds_read_b64_tr_b16 v[80:81], v10 offset:0
    ds_read_b64_tr_b16 v[82:83], v10 offset:1280
    v_mfma_f32_16x16x32_bf16 v[28:31], v[116:119], v[156:159], v[28:31]
    ds_read_b64_tr_b16 v[84:85], v10 offset:8
    ds_read_b64_tr_b16 v[86:87], v10 offset:1288
    v_mfma_f32_16x16x32_bf16 v[32:35], v[120:123], v[152:155], v[32:35]
    ds_read_b64_tr_b16 v[88:89], v10 offset:16
    ds_read_b64_tr_b16 v[90:91], v10 offset:1296
    v_mfma_f32_16x16x32_bf16 v[36:39], v[120:123], v[156:159], v[36:39]
    ds_read_b64_tr_b16 v[92:93], v10 offset:24
    ds_read_b64_tr_b16 v[94:95], v10 offset:1304
    v_mfma_f32_16x16x32_bf16 v[40:43], v[124:127], v[152:155], v[40:43]
    ds_read_b64_tr_b16 v[96:97], v10 offset:32
    ds_read_b64_tr_b16 v[98:99], v10 offset:1312
    v_mfma_f32_16x16x32_bf16 v[44:47], v[124:127], v[156:159], v[44:47]
    ds_read_b64_tr_b16 v[100:101], v11 offset:10240
    ds_read_b64_tr_b16 v[102:103], v11 offset:10320
    v_mfma_f32_16x16x32_bf16 v[48:51], v[128:131], v[152:155], v[48:51]
    ds_read_b64_tr_b16 v[104:105], v11 offset:10272
    ds_read_b64_tr_b16 v[106:107], v11 offset:10352
    v_mfma_f32_16x16x32_bf16 v[52:55], v[128:131], v[156:159], v[52:55]
    ds_read_b64_tr_b16 v[108:109], v11 offset:10304
    ds_read_b64_tr_b16 v[110:111], v11 offset:10384
    v_mfma_f32_16x16x32_bf16 v[56:59], v[132:135], v[152:155], v[56:59]
    s_mul_i32 s46, s39, 800
    v_mfma_f32_16x16x32_bf16 v[60:63], v[132:135], v[156:159], v[60:63]
    v_mfma_f32_16x16x32_bf16 v[64:67], v[136:139], v[152:155], v[64:67]
    v_mfma_f32_16x16x32_bf16 v[68:71], v[136:139], v[156:159], v[68:71]
    v_mfma_f32_16x16x32_bf16 v[72:75], v[140:143], v[152:155], v[72:75]
    v_mfma_f32_16x16x32_bf16 v[76:79], v[140:143], v[156:159], v[76:79]
    s_waitcnt lgkmcnt(0)
    v_mfma_f32_16x16x32_bf16 v[16:19], v[80:83], v[160:163], v[16:19]
    ds_read_b64_tr_b16 v[112:113], v10 offset:5120
    ds_read_b64_tr_b16 v[114:115], v10 offset:6400
    v_mfma_f32_16x16x32_bf16 v[20:23], v[80:83], v[164:167], v[20:23]
    ds_read_b64_tr_b16 v[116:117], v10 offset:5128
    ds_read_b64_tr_b16 v[118:119], v10 offset:6408
    v_mfma_f32_16x16x32_bf16 v[24:27], v[84:87], v[160:163], v[24:27]
    ds_read_b64_tr_b16 v[120:121], v10 offset:5136
    ds_read_b64_tr_b16 v[122:123], v10 offset:6416
    v_mfma_f32_16x16x32_bf16 v[28:31], v[84:87], v[164:167], v[28:31]
    ds_read_b64_tr_b16 v[124:125], v10 offset:5144
    ds_read_b64_tr_b16 v[126:127], v10 offset:6424
    v_mfma_f32_16x16x32_bf16 v[32:35], v[88:91], v[160:163], v[32:35]
    ds_read_b64_tr_b16 v[128:129], v10 offset:5152
    ds_read_b64_tr_b16 v[130:131], v10 offset:6432
    v_mfma_f32_16x16x32_bf16 v[36:39], v[88:91], v[164:167], v[36:39]
    ds_read_b64_tr_b16 v[132:133], v11 offset:12800
    ds_read_b64_tr_b16 v[134:135], v11 offset:12880
    v_mfma_f32_16x16x32_bf16 v[40:43], v[92:95], v[160:163], v[40:43]
    ds_read_b64_tr_b16 v[136:137], v11 offset:12832
    ds_read_b64_tr_b16 v[138:139], v11 offset:12912
    v_mfma_f32_16x16x32_bf16 v[44:47], v[92:95], v[164:167], v[44:47]
    ds_read_b64_tr_b16 v[140:141], v11 offset:12864
    ds_read_b64_tr_b16 v[142:143], v11 offset:12944
    v_mfma_f32_16x16x32_bf16 v[48:51], v[96:99], v[160:163], v[48:51]
    v_mfma_f32_16x16x32_bf16 v[52:55], v[96:99], v[164:167], v[52:55]
    v_mfma_f32_16x16x32_bf16 v[56:59], v[100:103], v[160:163], v[56:59]
    v_mfma_f32_16x16x32_bf16 v[60:63], v[100:103], v[164:167], v[60:63]
    v_mfma_f32_16x16x32_bf16 v[64:67], v[104:107], v[160:163], v[64:67]
    v_mfma_f32_16x16x32_bf16 v[68:71], v[104:107], v[164:167], v[68:71]
    v_mfma_f32_16x16x32_bf16 v[72:75], v[108:111], v[160:163], v[72:75]
    v_mfma_f32_16x16x32_bf16 v[76:79], v[108:111], v[164:167], v[76:79]
    s_waitcnt lgkmcnt(0)
    s_barrier
    v_mfma_f32_16x16x32_bf16 v[16:19], v[112:115], v[168:171], v[16:19]
    v_mfma_f32_16x16x32_bf16 v[20:23], v[112:115], v[172:175], v[20:23]
    v_mfma_f32_16x16x32_bf16 v[24:27], v[116:119], v[168:171], v[24:27]
    v_mfma_f32_16x16x32_bf16 v[28:31], v[116:119], v[172:175], v[28:31]
    v_mfma_f32_16x16x32_bf16 v[32:35], v[120:123], v[168:171], v[32:35]
    v_mfma_f32_16x16x32_bf16 v[36:39], v[120:123], v[172:175], v[36:39]
    v_mfma_f32_16x16x32_bf16 v[40:43], v[124:127], v[168:171], v[40:43]
    v_mfma_f32_16x16x32_bf16 v[44:47], v[124:127], v[172:175], v[44:47]
    v_mfma_f32_16x16x32_bf16 v[48:51], v[128:131], v[168:171], v[48:51]
    v_mfma_f32_16x16x32_bf16 v[52:55], v[128:131], v[172:175], v[52:55]
    v_mfma_f32_16x16x32_bf16 v[56:59], v[132:135], v[168:171], v[56:59]
    v_mfma_f32_16x16x32_bf16 v[60:63], v[132:135], v[172:175], v[60:63]
    v_mfma_f32_16x16x32_bf16 v[64:67], v[136:139], v[168:171], v[64:67]
    v_mfma_f32_16x16x32_bf16 v[68:71], v[136:139], v[172:175], v[68:71]
    v_mfma_f32_16x16x32_bf16 v[72:75], v[140:143], v[168:171], v[72:75]
    v_mfma_f32_16x16x32_bf16 v[76:79], v[140:143], v[172:175], v[76:79]
    v_cvt_pk_bf16_f32 v80, v16, v17
    v_cvt_pk_bf16_f32 v81, v18, v19
    v_cvt_pk_bf16_f32 v90, v20, v21
    v_cvt_pk_bf16_f32 v91, v22, v23
    v_cvt_pk_bf16_f32 v82, v24, v25
    v_cvt_pk_bf16_f32 v83, v26, v27
    v_cvt_pk_bf16_f32 v92, v28, v29
    v_cvt_pk_bf16_f32 v93, v30, v31
    v_cvt_pk_bf16_f32 v84, v32, v33
    v_cvt_pk_bf16_f32 v85, v34, v35
    v_cvt_pk_bf16_f32 v94, v36, v37
    v_cvt_pk_bf16_f32 v95, v38, v39
    v_cvt_pk_bf16_f32 v86, v40, v41
    v_cvt_pk_bf16_f32 v87, v42, v43
    v_cvt_pk_bf16_f32 v96, v44, v45
    v_cvt_pk_bf16_f32 v97, v46, v47
    v_cvt_pk_bf16_f32 v88, v48, v49
    v_cvt_pk_bf16_f32 v89, v50, v51
    v_cvt_pk_bf16_f32 v98, v52, v53
    v_cvt_pk_bf16_f32 v99, v54, v55
    s_nop 0
    v_permlane32_swap_b32 v88, v98
    v_permlane32_swap_b32 v89, v99
    v_permlane32_swap_b32 v80, v90
    v_permlane32_swap_b32 v81, v91
    v_permlane32_swap_b32 v82, v92
    v_permlane32_swap_b32 v83, v93
    v_permlane32_swap_b32 v84, v94
    v_permlane32_swap_b32 v85, v95
    v_permlane32_swap_b32 v86, v96
    v_permlane32_swap_b32 v87, v97
    v_mfma_f32_16x16x16_bf16 v[112:115], v[184:185], v[98:99], 0
    v_cvt_pk_bf16_f32 v100, v56, v57
    v_cvt_pk_bf16_f32 v101, v58, v59
    v_mfma_f32_16x16x16_bf16 v[116:119], v[194:195], v[98:99], 0
    ds_write_b64 v226, v[100:101] offset:51200
    v_mfma_f32_16x16x16_bf16 v[120:123], v[204:205], v[98:99], 0
    v_cvt_pk_bf16_f32 v102, v60, v61
    v_cvt_pk_bf16_f32 v103, v62, v63
    v_mfma_f32_16x16x16_bf16 v[124:127], v[214:215], v[98:99], 0
    ds_write_b64 v226, v[102:103] offset:52736
    v_mfma_f32_16x16x16_bf16 v[128:131], v[224:225], v[98:99], 0
    v_cvt_pk_bf16_f32 v104, v64, v65
    v_cvt_pk_bf16_f32 v105, v66, v67
    v_mfma_f32_16x16x32_bf16 v[112:115], v[176:179], v[90:93], v[112:115]
    ds_write_b64 v226, v[104:105] offset:51232
    v_mfma_f32_16x16x32_bf16 v[116:119], v[186:189], v[90:93], v[116:119]
    v_cvt_pk_bf16_f32 v106, v68, v69
    v_cvt_pk_bf16_f32 v107, v70, v71
    v_mfma_f32_16x16x32_bf16 v[120:123], v[196:199], v[90:93], v[120:123]
    ds_write_b64 v226, v[106:107] offset:52768
    v_mfma_f32_16x16x32_bf16 v[124:127], v[206:209], v[90:93], v[124:127]
    v_cvt_pk_bf16_f32 v108, v72, v73
    v_cvt_pk_bf16_f32 v109, v74, v75
    v_mfma_f32_16x16x32_bf16 v[128:131], v[216:219], v[90:93], v[128:131]
    ds_write_b64 v226, v[108:109] offset:51264
    v_mfma_f32_16x16x32_bf16 v[112:115], v[180:183], v[94:97], v[112:115]
    v_cvt_pk_bf16_f32 v110, v76, v77
    v_cvt_pk_bf16_f32 v111, v78, v79
    v_mfma_f32_16x16x32_bf16 v[116:119], v[190:193], v[94:97], v[116:119]
    ds_write_b64 v226, v[110:111] offset:52800
    v_mfma_f32_16x16x32_bf16 v[120:123], v[200:203], v[94:97], v[120:123]
    v_mfma_f32_16x16x32_bf16 v[124:127], v[210:213], v[94:97], v[124:127]
    v_mfma_f32_16x16x32_bf16 v[128:131], v[220:223], v[94:97], v[128:131]
    s_nop 0
    v_max3_f32 v132, v112, v113, v114
    s_add_u32 m0, s46, 25600
    s_mov_b32 exec_hi, 0x3ffff
    s_mul_i32 s45, s28, 204800
    buffer_load_dwordx4 v232, s[24:27], s45 offen lds
    s_mov_b32 exec_hi, -1
    v_min3_f32 v133, v112, v113, v114
    v_max3_f32 v134, v115, v116, v117
    v_min3_f32 v135, v115, v116, v117
    v_max3_f32 v132, v132, v118, v119
    v_min3_f32 v133, v133, v118, v119
    v_max3_f32 v134, v134, v120, v121
    v_min3_f32 v135, v135, v120, v121
    v_max3_f32 v132, v132, v122, v123
    v_min3_f32 v133, v133, v122, v123
    v_max3_f32 v134, v134, v124, v125
    v_min3_f32 v135, v135, v124, v125
    v_max3_f32 v132, v132, v126, v127
    s_add_u32 m0, s46, 28800
    s_mov_b32 exec_hi, 0x3ffff
    s_add_u32 s45, s45, 25600
    buffer_load_dwordx4 v232, s[24:27], s45 offen lds
    s_mov_b32 exec_hi, -1
    v_min3_f32 v133, v133, v126, v127
    v_max3_f32 v134, v134, v128, v129
    v_min3_f32 v135, v135, v128, v129
    v_max3_f32 v132, v132, v130, v131
    v_min3_f32 v133, v133, v130, v131
    v_max_f32 v132, v132, v134
    v_min_f32 v133, v133, v135
    v_mul_f32 v132, s50, v132
    v_fma_f32 v133, v133, s50, -v132
    v_fma_f32 v16, v112, s50, -v132
    v_fma_f32 v17, v113, s50, -v132
    v_fma_f32 v18, v114, s50, -v132
    s_add_u32 m0, s46, 32000
    s_mov_b32 exec_hi, 0x3ffff
    s_add_u32 s45, s45, 25600
    buffer_load_dwordx4 v232, s[24:27], s45 offen lds
    s_mov_b32 exec_hi, -1
    v_fma_f32 v19, v115, s50, -v132
    v_fma_f32 v20, v116, s50, -v132
    v_fma_f32 v21, v117, s50, -v132
    v_fma_f32 v22, v118, s50, -v132
    v_fma_f32 v23, v119, s50, -v132
    v_fma_f32 v24, v120, s50, -v132
    v_fma_f32 v25, v121, s50, -v132
    v_fma_f32 v26, v122, s50, -v132
    v_fma_f32 v27, v123, s50, -v132
    v_fma_f32 v28, v124, s50, -v132
    v_fma_f32 v29, v125, s50, -v132
    v_fma_f32 v30, v126, s50, -v132
    s_add_u32 m0, s46, 35200
    s_mov_b32 exec_hi, 0x3ffff
    s_add_u32 s45, s45, 25600
    buffer_load_dwordx4 v232, s[24:27], s45 offen lds
    s_mov_b32 exec_hi, -1
    v_fma_f32 v31, v127, s50, -v132
    v_fma_f32 v32, v128, s50, -v132
    v_fma_f32 v33, v129, s50, -v132
    v_fma_f32 v34, v130, s50, -v132
    v_fma_f32 v35, v131, s50, -v132
    v_sub_f32 v36, v133, v16
    v_exp_f32 v16, v16
    v_sub_f32 v37, v133, v17
    v_exp_f32 v17, v17
    v_sub_f32 v38, v133, v18
    v_exp_f32 v18, v18
    v_sub_f32 v39, v133, v19
    s_add_u32 m0, s46, 38400
    s_mov_b32 exec_hi, 0x3ffff
    s_add_u32 s45, s45, 25600
    buffer_load_dwordx4 v232, s[24:27], s45 offen lds
    s_mov_b32 exec_hi, -1
    v_exp_f32 v19, v19
    v_sub_f32 v40, v133, v20
    v_exp_f32 v20, v20
    v_sub_f32 v41, v133, v21
    v_exp_f32 v21, v21
    v_sub_f32 v42, v133, v22
    v_exp_f32 v22, v22
    v_sub_f32 v43, v133, v23
    v_exp_f32 v23, v23
    v_sub_f32 v44, v133, v24
    v_exp_f32 v24, v24
    v_sub_f32 v45, v133, v25
    s_add_u32 m0, s46, 41600
    s_mov_b32 exec_hi, 0x3ffff
    s_add_u32 s45, s45, 25600
    buffer_load_dwordx4 v232, s[24:27], s45 offen lds
    s_mov_b32 exec_hi, -1
    v_exp_f32 v25, v25
    v_sub_f32 v46, v133, v26
    v_exp_f32 v26, v26
    v_sub_f32 v47, v133, v27
    v_exp_f32 v27, v27
    v_sub_f32 v48, v133, v28
    v_exp_f32 v28, v28
    v_sub_f32 v49, v133, v29
    v_exp_f32 v29, v29
    v_sub_f32 v50, v133, v30
    v_exp_f32 v30, v30
    v_sub_f32 v51, v133, v31
    s_add_u32 m0, s46, 44800
    s_mov_b32 exec_hi, 0x3ffff
    s_add_u32 s45, s45, 25600
    buffer_load_dwordx4 v232, s[24:27], s45 offen lds
    s_mov_b32 exec_hi, -1
    v_exp_f32 v31, v31
    v_sub_f32 v52, v133, v32
    v_exp_f32 v32, v32
    v_sub_f32 v53, v133, v33
    v_exp_f32 v33, v33
    v_sub_f32 v54, v133, v34
    v_exp_f32 v34, v34
    v_sub_f32 v55, v133, v35
    v_exp_f32 v35, v35
    v_exp_f32 v36, v36
    v_add_f32 v134, v16, v17
    v_exp_f32 v37, v37
    s_add_u32 m0, s46, 48000
    s_mov_b32 exec_hi, 0x3ffff
    s_add_u32 s45, s45, 25600
    buffer_load_dwordx4 v232, s[24:27], s45 offen lds
    s_mov_b32 exec_hi, -1
    v_add_f32 v136, v18, v19
    v_exp_f32 v38, v38
    v_add_f32 v134, v134, v20
    v_exp_f32 v39, v39
    v_add_f32 v136, v136, v21
    v_exp_f32 v40, v40
    v_add_f32 v134, v134, v22
    v_exp_f32 v41, v41
    v_add_f32 v136, v136, v23
    v_exp_f32 v42, v42
    v_add_f32 v134, v134, v24
    v_exp_f32 v43, v43
    v_add_f32 v136, v136, v25
    v_exp_f32 v44, v44
    v_add_f32 v134, v134, v26
    v_exp_f32 v45, v45
    v_add_f32 v136, v136, v27
    v_exp_f32 v46, v46
    v_add_f32 v134, v134, v28
    v_exp_f32 v47, v47
    v_add_f32 v136, v136, v29
    v_exp_f32 v48, v48
    v_add_f32 v134, v134, v30
    v_exp_f32 v49, v49
    v_add_f32 v136, v136, v31
    v_exp_f32 v50, v50
    v_add_f32 v134, v134, v32
    v_exp_f32 v51, v51
    v_add_f32 v136, v136, v33
    v_exp_f32 v52, v52
    v_add_f32 v134, v134, v34
    v_exp_f32 v53, v53
    v_add_f32 v136, v136, v35
    v_exp_f32 v54, v54
    v_add_f32 v134, v134, v136
    v_exp_f32 v55, v55
    v_rcp_f32 v134, v134
    v_add_f32 v135, v36, v37
    v_add_f32 v137, v38, v39
    v_add_f32 v135, v135, v40
    v_add_f32 v137, v137, v41
    v_add_f32 v135, v135, v42
    v_add_f32 v137, v137, v43
    v_add_f32 v135, v135, v44
    v_add_f32 v137, v137, v45
    v_add_f32 v135, v135, v46
    v_add_f32 v137, v137, v47
    v_add_f32 v135, v135, v48
    v_add_f32 v137, v137, v49
    v_add_f32 v135, v135, v50
    v_add_f32 v137, v137, v51
    v_add_f32 v135, v135, v52
    v_add_f32 v137, v137, v53
    v_add_f32 v135, v135, v54
    v_add_f32 v137, v137, v55
    v_add_f32 v135, v135, v137
    v_rcp_f32 v135, v135
    v_mul_f32 v16, v134, v16
    v_mul_f32 v17, v134, v17
    v_mul_f32 v18, v134, v18
    v_mul_f32 v19, v134, v19
    v_mul_f32 v20, v134, v20
    v_mul_f32 v21, v134, v21
    v_mul_f32 v22, v134, v22
    v_mul_f32 v23, v134, v23
    v_mul_f32 v24, v134, v24
    v_mul_f32 v25, v134, v25
    v_mul_f32 v26, v134, v26
    v_mul_f32 v27, v134, v27
    v_mul_f32 v28, v134, v28
    v_mul_f32 v29, v134, v29
    v_mul_f32 v30, v134, v30
    v_mul_f32 v31, v134, v31
    v_mul_f32 v32, v134, v32
    v_mul_f32 v33, v134, v33
    v_mul_f32 v34, v134, v34
    v_mul_f32 v35, v134, v35
    v_mul_f32 v36, v135, v36
    v_mul_f32 v37, v135, v37
    v_mul_f32 v38, v135, v38
    v_mul_f32 v39, v135, v39
    v_mul_f32 v40, v135, v40
    v_mul_f32 v41, v135, v41
    v_mul_f32 v42, v135, v42
    v_mul_f32 v43, v135, v43
    v_mul_f32 v44, v135, v44
    v_mul_f32 v45, v135, v45
    v_mul_f32 v46, v135, v46
    v_mul_f32 v47, v135, v47
    v_mul_f32 v48, v135, v48
    v_mul_f32 v49, v135, v49
    v_mul_f32 v50, v135, v50
    v_mul_f32 v51, v135, v51
    v_mul_f32 v52, v135, v52
    v_mul_f32 v53, v135, v53
    v_mul_f32 v54, v135, v54
    v_mul_f32 v55, v135, v55
    v_cvt_pk_bf16_f32 v132, v16, v17
    v_cvt_pk_bf16_f32 v133, v18, v19
    v_cvt_pk_bf16_f32 v134, v20, v21
    v_cvt_pk_bf16_f32 v135, v22, v23
    v_cvt_pk_bf16_f32 v136, v24, v25
    ds_write_b128 v227, v[132:135] offset:0
    v_cvt_pk_bf16_f32 v137, v26, v27
    v_cvt_pk_bf16_f32 v138, v28, v29
    v_cvt_pk_bf16_f32 v139, v30, v31
    v_cvt_pk_bf16_f32 v140, v32, v33
    ds_write_b128 v227, v[136:139] offset:16
    v_cvt_pk_bf16_f32 v141, v34, v35
    v_cvt_pk_bf16_f32 v142, v36, v37
    v_cvt_pk_bf16_f32 v143, v38, v39
    v_cvt_pk_bf16_f32 v144, v40, v41
    ds_write_b128 v227, v[140:143] offset:32
    v_cvt_pk_bf16_f32 v145, v42, v43
    v_cvt_pk_bf16_f32 v146, v44, v45
    v_cvt_pk_bf16_f32 v147, v46, v47
    v_cvt_pk_bf16_f32 v148, v48, v49
    ds_write_b128 v227, v[144:147] offset:48
    v_cvt_pk_bf16_f32 v149, v50, v51
    v_cvt_pk_bf16_f32 v150, v52, v53
    v_cvt_pk_bf16_f32 v151, v54, v55
    ds_write_b128 v227, v[148:151] offset:64
    s_waitcnt vmcnt(0) lgkmcnt(0)
    s_barrier
    ds_read_b64_tr_b16 v[152:153], v228 offset:51200
    ds_read_b64_tr_b16 v[154:155], v228 offset:52736
    ds_read_b64_tr_b16 v[156:157], v228 offset:54272
    ds_read_b64_tr_b16 v[158:159], v228 offset:55808
    ds_read_b64_tr_b16 v[160:161], v228 offset:57344
    ds_read_b64_tr_b16 v[162:163], v228 offset:58880
    ds_read_b64_tr_b16 v[164:165], v228 offset:60416
    ds_read_b64_tr_b16 v[166:167], v228 offset:61952
    ds_read_b64_tr_b16 v[16:17], v229 offset:0
    ds_read_b64_tr_b16 v[18:19], v229 offset:2560
    ds_read_b64_tr_b16 v[20:21], v229 offset:32
    ds_read_b64_tr_b16 v[22:23], v229 offset:2592
    ds_read_b64_tr_b16 v[24:25], v229 offset:64
    ds_read_b64_tr_b16 v[26:27], v229 offset:2624
    ds_read_b64_tr_b16 v[28:29], v229 offset:5120
    ds_read_b64_tr_b16 v[30:31], v229 offset:7680
    ds_read_b64_tr_b16 v[32:33], v229 offset:5152
    ds_read_b64_tr_b16 v[34:35], v229 offset:7712
    ds_read_b64_tr_b16 v[36:37], v229 offset:5184
    ds_read_b64_tr_b16 v[38:39], v229 offset:7744
    s_waitcnt lgkmcnt(12)
    v_cndmask_b32 v152, v152, v233, s[56:57]
    v_cndmask_b32 v153, v153, v233, s[56:57]
    v_cndmask_b32 v154, v154, v233, s[56:57]
    v_cndmask_b32 v155, v155, v233, s[56:57]
    v_cndmask_b32 v156, v156, v233, s[56:57]
    v_cndmask_b32 v157, v157, v233, s[56:57]
    v_cndmask_b32 v158, v158, v233, s[56:57]
    v_cndmask_b32 v159, v159, v233, s[56:57]
    v_cndmask_b32 v160, v160, v233, s[56:57]
    v_cndmask_b32 v161, v161, v233, s[56:57]
    v_cndmask_b32 v162, v162, v233, s[56:57]
    v_cndmask_b32 v163, v163, v233, s[56:57]
    v_cndmask_b32 v164, v164, v233, s[56:57]
    v_cndmask_b32 v165, v165, v233, s[56:57]
    v_cndmask_b32 v166, v166, v233, s[56:57]
    v_cndmask_b32 v167, v167, v233, s[56:57]
    ds_read_b64_tr_b16 v[40:41], v229 offset:10240
    ds_read_b64_tr_b16 v[42:43], v229 offset:12800
    ds_read_b64_tr_b16 v[44:45], v229 offset:10272
    ds_read_b64_tr_b16 v[46:47], v229 offset:12832
    ds_read_b64_tr_b16 v[48:49], v229 offset:10304
    ds_read_b64_tr_b16 v[50:51], v229 offset:12864
    ds_read_b64_tr_b16 v[52:53], v229 offset:15360
    ds_read_b64_tr_b16 v[54:55], v229 offset:17920
    ds_read_b64_tr_b16 v[56:57], v229 offset:15392
    ds_read_b64_tr_b16 v[58:59], v229 offset:17952
    ds_read_b64_tr_b16 v[60:61], v229 offset:15424
    ds_read_b64_tr_b16 v[62:63], v229 offset:17984
    s_waitcnt lgkmcnt(12)
    v_mfma_f32_16x16x32_bf16 v[64:67], v[152:155], v[16:19], 0
    v_mfma_f32_16x16x32_bf16 v[68:71], v[152:155], v[20:23], 0
    v_mfma_f32_16x16x32_bf16 v[72:75], v[152:155], v[24:27], 0
    s_waitcnt lgkmcnt(12)
    v_mfma_f32_16x16x32_bf16 v[64:67], v[156:159], v[28:31], v[64:67]
    v_mfma_f32_16x16x32_bf16 v[68:71], v[156:159], v[32:35], v[68:71]
    v_mfma_f32_16x16x32_bf16 v[72:75], v[156:159], v[36:39], v[72:75]
    s_waitcnt lgkmcnt(6)
    v_mfma_f32_16x16x32_bf16 v[64:67], v[160:163], v[40:43], v[64:67]
    v_mfma_f32_16x16x32_bf16 v[68:71], v[160:163], v[44:47], v[68:71]
    v_mfma_f32_16x16x32_bf16 v[72:75], v[160:163], v[48:51], v[72:75]
    s_waitcnt lgkmcnt(0)
    v_mfma_f32_16x16x32_bf16 v[64:67], v[164:167], v[52:55], v[64:67]
    v_mfma_f32_16x16x32_bf16 v[68:71], v[164:167], v[56:59], v[68:71]
    v_mfma_f32_16x16x32_bf16 v[72:75], v[164:167], v[60:63], v[72:75]
    ds_read_b64_tr_b16 v[184:185], v246 offset:640
    ds_read_b64_tr_b16 v[194:195], v246 offset:648
    ds_read_b64_tr_b16 v[204:205], v246 offset:656
    ds_read_b64_tr_b16 v[214:215], v246 offset:664
    ds_read_b64_tr_b16 v[224:225], v246 offset:672
    ds_read_b64_tr_b16 v[176:177], v246 offset:0
    ds_read_b64_tr_b16 v[186:187], v246 offset:8
    ds_read_b64_tr_b16 v[196:197], v246 offset:16
    v_cvt_pk_bf16_f32 v168, v64, v65
    v_cvt_pk_bf16_f32 v169, v66, v67
    v_cvt_pk_bf16_f32 v170, v68, v69
    v_cvt_pk_bf16_f32 v171, v70, v71
    v_cvt_pk_bf16_f32 v172, v72, v73
    v_cvt_pk_bf16_f32 v173, v74, v75
    buffer_store_dwordx4 v[168:171], v230, s[16:19], s32 offen sc1
    v_mov_b32_dpp v174, v172 quad_perm:[1,1,3,3] row_mask:0xf bank_mask:0xf
    v_mov_b32_dpp v175, v173 quad_perm:[1,1,3,3] row_mask:0xf bank_mask:0xf
    buffer_store_dwordx4 v[172:175], v231, s[16:19], s32 offen sc1
    buffer_store_dword v249, v243, s[16:19], s35 offen sc1
    ds_read_b64_tr_b16 v[206:207], v246 offset:24
    ds_read_b64_tr_b16 v[216:217], v246 offset:32
    ds_read_b64_tr_b16 v[178:179], v246 offset:160
    ds_read_b64_tr_b16 v[188:189], v246 offset:168
    ds_read_b64_tr_b16 v[198:199], v246 offset:176
    ds_read_b64_tr_b16 v[208:209], v246 offset:184
    ds_read_b64_tr_b16 v[218:219], v246 offset:192
    ds_read_b64_tr_b16 v[180:181], v246 offset:320
    ds_read_b64_tr_b16 v[190:191], v246 offset:328
    ds_read_b64_tr_b16 v[200:201], v246 offset:336
    ds_read_b64_tr_b16 v[210:211], v246 offset:344
    ds_read_b64_tr_b16 v[220:221], v246 offset:352
    ds_read_b64_tr_b16 v[182:183], v246 offset:480
    ds_read_b64_tr_b16 v[192:193], v246 offset:488
    ds_read_b64_tr_b16 v[202:203], v246 offset:496
    ds_read_b64_tr_b16 v[212:213], v246 offset:504
    ds_read_b64_tr_b16 v[222:223], v246 offset:512
    s_xor_b32 s44, s36, 1
    s_mul_i32 s44, s44, 65536
    v_mov_b32 v2, v238
    v_mov_b32 v3, v240
    v_mov_b32 v4, v241
    v_add_u32 v5, 25600, v240
    v_add_u32 v6, 25600, v241
    v_mov_b32 v7, v242
    v_mov_b32 v8, v244
    v_mov_b32 v9, v232
    v_mov_b32 v10, v239
    v_mov_b32 v11, v237
    v_mov_b32 v1, v12
    v_mov_b32 v12, v234
    v_mov_b32 v13, v235
    v_mov_b32 v14, v236
    v_mov_b32 v15, v243
    s_waitcnt lgkmcnt(0)
    s_barrier
    v_mfma_f32_16x16x16_bf16 v[112:115], v[184:185], v[88:89], 0
    v_mov_b32 v240, v250
    v_mfma_f32_16x16x16_bf16 v[116:119], v[194:195], v[88:89], 0
    v_mov_b32 v241, v251
    v_mfma_f32_16x16x16_bf16 v[120:123], v[204:205], v[88:89], 0
    v_mov_b32 v242, 0
    v_mfma_f32_16x16x16_bf16 v[124:127], v[214:215], v[88:89], 0
    v_mov_b32 v243, 0
    v_mfma_f32_16x16x16_bf16 v[128:131], v[224:225], v[88:89], 0
    v_mov_b32 v244, 0
    v_mfma_f32_16x16x32_bf16 v[112:115], v[176:179], v[80:83], v[112:115]
    v_mov_b32 v245, 0
    v_mfma_f32_16x16x32_bf16 v[116:119], v[186:189], v[80:83], v[116:119]
    v_mov_b32 v246, v250
    v_mfma_f32_16x16x32_bf16 v[120:123], v[196:199], v[80:83], v[120:123]
    v_mov_b32 v247, v251
    v_mfma_f32_16x16x32_bf16 v[124:127], v[206:209], v[80:83], v[124:127]
    v_mfma_f32_16x16x32_bf16 v[128:131], v[216:219], v[80:83], v[128:131]
    v_mfma_f32_16x16x32_bf16 v[112:115], v[180:183], v[84:87], v[112:115]
    v_mfma_f32_16x16x32_bf16 v[116:119], v[190:193], v[84:87], v[116:119]
    v_mfma_f32_16x16x32_bf16 v[120:123], v[200:203], v[84:87], v[120:123]
    v_mfma_f32_16x16x32_bf16 v[124:127], v[210:213], v[84:87], v[124:127]
    v_mfma_f32_16x16x32_bf16 v[128:131], v[220:223], v[84:87], v[128:131]
    s_nop 3
    v_max3_f32 v56, v112, v113, v114
    s_add_u32 m0, s46, 51200
    s_mov_b32 exec_hi, 0x3ffff
    s_mul_i32 s45, s29, 204800
    buffer_load_dwordx4 v9, s[24:27], s45 offen lds
    s_mov_b32 exec_hi, -1
    v_min3_f32 v57, v112, v113, v114
    v_max3_f32 v58, v115, v116, v117
    v_min3_f32 v59, v115, v116, v117
    v_max3_f32 v56, v56, v118, v119
    v_min3_f32 v57, v57, v118, v119
    v_max3_f32 v58, v58, v120, v121
    v_min3_f32 v59, v59, v120, v121
    v_max3_f32 v56, v56, v122, v123
    v_min3_f32 v57, v57, v122, v123
    v_max3_f32 v58, v58, v124, v125
    s_add_u32 m0, s46, 54400
    s_mov_b32 exec_hi, 0x3ffff
    s_add_u32 s45, s45, 25600
    buffer_load_dwordx4 v9, s[24:27], s45 offen lds
    s_mov_b32 exec_hi, -1
    v_min3_f32 v59, v59, v124, v125
    v_max3_f32 v56, v56, v126, v127
    v_min3_f32 v57, v57, v126, v127
    v_max3_f32 v58, v58, v128, v129
    v_min3_f32 v59, v59, v128, v129
    v_max3_f32 v56, v56, v130, v131
    v_min3_f32 v57, v57, v130, v131
    v_max_f32 v56, v56, v58
    v_min_f32 v57, v57, v59
    v_mul_f32 v56, s50, v56
    s_add_u32 m0, s46, 57600
    s_mov_b32 exec_hi, 0x3ffff
    s_add_u32 s45, s45, 25600
    buffer_load_dwordx4 v9, s[24:27], s45 offen lds
    s_mov_b32 exec_hi, -1
    v_fma_f32 v57, v57, s50, -v56
    v_fma_f32 v16, v112, s50, -v56
    v_fma_f32 v17, v113, s50, -v56
    v_fma_f32 v18, v114, s50, -v56
    v_fma_f32 v19, v115, s50, -v56
    v_fma_f32 v20, v116, s50, -v56
    v_fma_f32 v21, v117, s50, -v56
    v_fma_f32 v22, v118, s50, -v56
    v_fma_f32 v23, v119, s50, -v56
    v_fma_f32 v24, v120, s50, -v56
    s_add_u32 m0, s46, 60800
    s_mov_b32 exec_hi, 0x3ffff
    s_add_u32 s45, s45, 25600
    buffer_load_dwordx4 v9, s[24:27], s45 offen lds
    s_mov_b32 exec_hi, -1
    v_fma_f32 v25, v121, s50, -v56
    v_fma_f32 v26, v122, s50, -v56
    v_fma_f32 v27, v123, s50, -v56
    v_fma_f32 v28, v124, s50, -v56
    v_fma_f32 v29, v125, s50, -v56
    v_fma_f32 v30, v126, s50, -v56
    v_fma_f32 v31, v127, s50, -v56
    v_fma_f32 v32, v128, s50, -v56
    v_fma_f32 v33, v129, s50, -v56
    v_fma_f32 v34, v130, s50, -v56
    s_add_u32 m0, s46, 64000
    s_mov_b32 exec_hi, 0x3ffff
    s_add_u32 s45, s45, 25600
    buffer_load_dwordx4 v9, s[24:27], s45 offen lds
    s_mov_b32 exec_hi, -1
    v_fma_f32 v35, v131, s50, -v56
    v_sub_f32 v36, v57, v16
    v_exp_f32 v16, v16
    v_sub_f32 v37, v57, v17
    v_exp_f32 v17, v17
    v_sub_f32 v38, v57, v18
    v_exp_f32 v18, v18
    v_sub_f32 v39, v57, v19
    v_exp_f32 v19, v19
    v_sub_f32 v40, v57, v20
    s_add_u32 m0, s46, 67200
    s_mov_b32 exec_hi, 0x3ffff
    s_add_u32 s45, s45, 25600
    buffer_load_dwordx4 v9, s[24:27], s45 offen lds
    s_mov_b32 exec_hi, -1
    v_exp_f32 v20, v20
    v_sub_f32 v41, v57, v21
    v_exp_f32 v21, v21
    v_sub_f32 v42, v57, v22
    v_exp_f32 v22, v22
    v_sub_f32 v43, v57, v23
    v_exp_f32 v23, v23
    v_sub_f32 v44, v57, v24
    v_exp_f32 v24, v24
    v_sub_f32 v45, v57, v25
    s_add_u32 m0, s46, 70400
    s_mov_b32 exec_hi, 0x3ffff
    s_add_u32 s45, s45, 25600
    buffer_load_dwordx4 v9, s[24:27], s45 offen lds
    s_mov_b32 exec_hi, -1
    v_exp_f32 v25, v25
    v_sub_f32 v46, v57, v26
    v_exp_f32 v26, v26
    v_sub_f32 v47, v57, v27
    v_exp_f32 v27, v27
    v_sub_f32 v48, v57, v28
    v_exp_f32 v28, v28
    v_sub_f32 v49, v57, v29
    v_exp_f32 v29, v29
    v_sub_f32 v50, v57, v30
    s_add_u32 m0, s46, 73600
    s_mov_b32 exec_hi, 0x3ffff
    s_add_u32 s45, s45, 25600
    buffer_load_dwordx4 v9, s[24:27], s45 offen lds
    s_mov_b32 exec_hi, -1
    v_exp_f32 v30, v30
    v_sub_f32 v51, v57, v31
    v_exp_f32 v31, v31
    v_sub_f32 v52, v57, v32
    v_exp_f32 v32, v32
    v_sub_f32 v53, v57, v33
    v_exp_f32 v33, v33
    v_sub_f32 v54, v57, v34
    v_exp_f32 v34, v34
    v_sub_f32 v55, v57, v35
    v_exp_f32 v35, v35
    v_exp_f32 v36, v36
    v_add_f32 v58, v16, v17
    v_exp_f32 v37, v37
    v_add_f32 v60, v18, v19
    v_exp_f32 v38, v38
    v_add_f32 v58, v58, v20
    v_exp_f32 v39, v39
    v_add_f32 v60, v60, v21
    v_exp_f32 v40, v40
    v_add_f32 v58, v58, v22
    v_exp_f32 v41, v41
    v_add_f32 v60, v60, v23
    v_exp_f32 v42, v42
    v_add_f32 v58, v58, v24
    v_exp_f32 v43, v43
    v_add_f32 v60, v60, v25
    v_exp_f32 v44, v44
    v_add_f32 v58, v58, v26
    v_exp_f32 v45, v45
    v_add_f32 v60, v60, v27
    v_exp_f32 v46, v46
    v_add_f32 v58, v58, v28
    v_exp_f32 v47, v47
    v_add_f32 v60, v60, v29
    v_exp_f32 v48, v48
    v_add_f32 v58, v58, v30
    v_exp_f32 v49, v49
    v_add_f32 v60, v60, v31
    v_exp_f32 v50, v50
    v_add_f32 v58, v58, v32
    v_exp_f32 v51, v51
    v_add_f32 v60, v60, v33
    v_exp_f32 v52, v52
    v_add_f32 v58, v58, v34
    v_exp_f32 v53, v53
    v_add_f32 v60, v60, v35
    v_exp_f32 v54, v54
    v_add_f32 v58, v58, v60
    v_exp_f32 v55, v55
    v_rcp_f32 v58, v58
    v_add_f32 v59, v36, v37
    v_add_f32 v61, v38, v39
    v_add_f32 v59, v59, v40
    v_add_f32 v61, v61, v41
    v_add_f32 v59, v59, v42
    v_add_f32 v61, v61, v43
    v_add_f32 v59, v59, v44
    v_add_f32 v61, v61, v45
    v_add_f32 v59, v59, v46
    v_add_f32 v61, v61, v47
    v_add_f32 v59, v59, v48
    v_add_f32 v61, v61, v49
    v_add_f32 v59, v59, v50
    v_add_f32 v61, v61, v51
    v_add_f32 v59, v59, v52
    v_add_f32 v61, v61, v53
    v_add_f32 v59, v59, v54
    v_add_f32 v61, v61, v55
    v_add_f32 v59, v59, v61
    v_rcp_f32 v59, v59
    v_mul_f32 v16, v58, v16
    v_mul_f32 v17, v58, v17
    v_mul_f32 v18, v58, v18
    v_mul_f32 v19, v58, v19
    v_mul_f32 v20, v58, v20
    v_mul_f32 v21, v58, v21
    v_mul_f32 v22, v58, v22
    v_mul_f32 v23, v58, v23
    v_mul_f32 v24, v58, v24
    v_mul_f32 v25, v58, v25
    v_mul_f32 v26, v58, v26
    v_mul_f32 v27, v58, v27
    v_mul_f32 v28, v58, v28
    v_mul_f32 v29, v58, v29
    v_mul_f32 v30, v58, v30
    v_mul_f32 v31, v58, v31
    v_mul_f32 v32, v58, v32
    v_mul_f32 v33, v58, v33
    v_mul_f32 v34, v58, v34
    v_mul_f32 v35, v58, v35
    v_mul_f32 v36, v59, v36
    v_mul_f32 v37, v59, v37
    v_mul_f32 v38, v59, v38
    v_mul_f32 v39, v59, v39
    v_mul_f32 v40, v59, v40
    v_mul_f32 v41, v59, v41
    v_mul_f32 v42, v59, v42
    v_mul_f32 v43, v59, v43
    v_mul_f32 v44, v59, v44
    s_mov_b64 exec, 0xffff
    buffer_load_dword v248, v12, s[16:19], 0 offen sc1
    s_mov_b64 exec, -1
    v_mul_f32 v45, v59, v45
    v_mul_f32 v46, v59, v46
    v_mul_f32 v47, v59, v47
    v_mul_f32 v48, v59, v48
    v_mul_f32 v49, v59, v49
    v_mul_f32 v50, v59, v50
    v_mul_f32 v51, v59, v51
    v_mul_f32 v52, v59, v52
    v_mul_f32 v53, v59, v53
    v_mul_f32 v54, v59, v54
    v_mul_f32 v55, v59, v55
    v_cvt_pk_bf16_f32 v56, v16, v17
    v_cvt_pk_bf16_f32 v57, v18, v19
    v_cvt_pk_bf16_f32 v58, v20, v21
    v_cvt_pk_bf16_f32 v59, v22, v23
    v_cvt_pk_bf16_f32 v60, v24, v25
    v_cvt_pk_bf16_f32 v61, v26, v27
    v_cvt_pk_bf16_f32 v62, v28, v29
    v_cvt_pk_bf16_f32 v63, v30, v31
    v_cvt_pk_bf16_f32 v64, v32, v33
    v_cvt_pk_bf16_f32 v65, v34, v35
    v_cvt_pk_bf16_f32 v66, v36, v37
    v_cvt_pk_bf16_f32 v67, v38, v39
    v_cvt_pk_bf16_f32 v68, v40, v41
    v_cvt_pk_bf16_f32 v69, v42, v43
    v_cvt_pk_bf16_f32 v70, v44, v45
    v_cvt_pk_bf16_f32 v71, v46, v47
    v_cvt_pk_bf16_f32 v72, v48, v49
    v_cvt_pk_bf16_f32 v73, v50, v51
    v_cvt_pk_bf16_f32 v74, v52, v53
    v_cvt_pk_bf16_f32 v75, v54, v55
    v_permlane32_swap_b32 v56, v66
    v_permlane32_swap_b32 v57, v67
    v_permlane32_swap_b32 v58, v68
    v_permlane32_swap_b32 v59, v69
    v_permlane32_swap_b32 v60, v70
    v_permlane32_swap_b32 v61, v71
    v_permlane32_swap_b32 v62, v72
    v_permlane32_swap_b32 v63, v73
    v_permlane32_swap_b32 v64, v74
    v_permlane32_swap_b32 v65, v75
    s_waitcnt vmcnt(9)
    s_barrier
    s_mov_b32 s52, 0
    s_mov_b32 s49, 0
    s_add_u32 s43, s33, 20480
    s_add_u32 s41, s3, 16384
L_B_ex1:
    s_waitcnt vmcnt(0)
    v_cmp_ne_u32 vcc, s62, v248
    s_add_u32 s52, s52, 1
    s_and_b32 s54, vcc_lo, 0xffff
    s_nop 2
    s_cbranch_scc0 L_B_ex1_go
    s_cmp_ge_u32 s52, 4000
    s_cbranch_scc1 L_B_ex1_go
L_B_ex1_again:
    s_mov_b64 exec, 0xffff
    buffer_load_dword v248, v12, s[16:19], 0 offen sc1
    s_mov_b64 exec, -1
    s_cmp_lg_u32 s49, 0
    s_cbranch_scc1 L_B_ex1
    s_mov_b32 s49, 1
    ds_read_b64_tr_b16 v[76:77], v5 offset:0
    ds_read_b64_tr_b16 v[78:79], v5 offset:640
    ds_read_b64_tr_b16 v[80:81], v5 offset:8
    ds_read_b64_tr_b16 v[82:83], v5 offset:648
    ds_read_b64_tr_b16 v[84:85], v5 offset:16
    ds_read_b64_tr_b16 v[86:87], v5 offset:656
    ds_read_b64_tr_b16 v[88:89], v5 offset:24
    ds_read_b64_tr_b16 v[90:91], v5 offset:664
    ds_read_b64_tr_b16 v[92:93], v5 offset:32
    ds_read_b64_tr_b16 v[94:95], v5 offset:672
    ds_read_b64_tr_b16 v[96:97], v5 offset:6400
    ds_read_b64_tr_b16 v[98:99], v5 offset:7040
    ds_read_b64_tr_b16 v[100:101], v5 offset:6408
    ds_read_b64_tr_b16 v[102:103], v5 offset:7048
    ds_read_b64_tr_b16 v[104:105], v5 offset:6416
    ds_read_b64_tr_b16 v[106:107], v5 offset:7056
    ds_read_b64_tr_b16 v[108:109], v5 offset:6424
    ds_read_b64_tr_b16 v[110:111], v5 offset:7064
    ds_read_b64_tr_b16 v[112:113], v5 offset:6432
    ds_read_b64_tr_b16 v[114:115], v5 offset:7072
    ds_read_b64_tr_b16 v[116:117], v5 offset:12800
    ds_read_b64_tr_b16 v[118:119], v5 offset:13440
    ds_read_b64_tr_b16 v[120:121], v5 offset:12808
    ds_read_b64_tr_b16 v[122:123], v5 offset:13448
    ds_read_b64_tr_b16 v[124:125], v5 offset:12816
    ds_read_b64_tr_b16 v[126:127], v5 offset:13456
    ds_read_b64_tr_b16 v[128:129], v5 offset:12824
    ds_read_b64_tr_b16 v[130:131], v5 offset:13464
    ds_read_b64_tr_b16 v[132:133], v5 offset:12832
    ds_read_b64_tr_b16 v[134:135], v5 offset:13472
    ds_read_b64_tr_b16 v[136:137], v5 offset:19200
    ds_read_b64_tr_b16 v[138:139], v5 offset:19840
    ds_read_b64_tr_b16 v[140:141], v5 offset:19208
    ds_read_b64_tr_b16 v[142:143], v5 offset:19848
    ds_read_b64_tr_b16 v[144:145], v5 offset:19216
    ds_read_b64_tr_b16 v[146:147], v5 offset:19856
    ds_read_b64_tr_b16 v[148:149], v5 offset:19224
    ds_read_b64_tr_b16 v[150:151], v5 offset:19864
    ds_read_b64_tr_b16 v[152:153], v5 offset:19232
    ds_read_b64_tr_b16 v[154:155], v5 offset:19872
    ds_read_b64_tr_b16 v[156:157], v6 offset:0
    ds_read_b64_tr_b16 v[158:159], v6 offset:3200
    ds_read_b64_tr_b16 v[160:161], v6 offset:8
    ds_read_b64_tr_b16 v[162:163], v6 offset:3208
    ds_read_b64_tr_b16 v[164:165], v6 offset:16
    ds_read_b64_tr_b16 v[166:167], v6 offset:3216
    ds_read_b64_tr_b16 v[168:169], v6 offset:24
    ds_read_b64_tr_b16 v[170:171], v6 offset:3224
    ds_read_b64_tr_b16 v[172:173], v6 offset:32
    ds_read_b64_tr_b16 v[174:175], v6 offset:3232
    s_branch L_B_ex1
L_B_ex1_go:
    s_add_u32 s40, s44, 0
    buffer_load_dwordx4 v[176:179], v13, s[16:19], s40 offen sc1
    s_add_u32 s40, s44, 4096
    buffer_load_dwordx4 v[180:183], v13, s[16:19], s40 offen sc1
    s_add_u32 s40, s44, 8192
    buffer_load_dwordx4 v[184:187], v13, s[16:19], s40 offen sc1
    s_add_u32 s40, s44, 12288
    buffer_load_dwordx4 v[188:191], v13, s[16:19], s40 offen sc1
    s_add_u32 s40, s44, 16384
    buffer_load_dwordx4 v[192:195], v13, s[16:19], s40 offen sc1
    s_add_u32 s40, s44, 20480
    buffer_load_dwordx4 v[196:199], v13, s[16:19], s40 offen sc1
    s_add_u32 s40, s44, 24576
    buffer_load_dwordx4 v[200:203], v13, s[16:19], s40 offen sc1
    s_add_u32 s40, s44, 28672
    buffer_load_dwordx4 v[204:207], v13, s[16:19], s40 offen sc1
    s_add_u32 s40, s44, 32768
    buffer_load_dwordx4 v[208:211], v13, s[16:19], s40 offen sc1
    s_add_u32 s40, s44, 36864
    buffer_load_dwordx4 v[212:215], v13, s[16:19], s40 offen sc1
    s_add_u32 s40, s44, 40960
    buffer_load_dwordx4 v[216:219], v13, s[16:19], s40 offen sc1
    s_add_u32 s40, s44, 45056
    buffer_load_dwordx4 v[220:223], v13, s[16:19], s40 offen sc1
    s_add_u32 s40, s44, 49152
    buffer_load_dwordx4 v[224:227], v13, s[16:19], s40 offen sc1
    s_add_u32 s40, s44, 53248
    buffer_load_dwordx4 v[228:231], v13, s[16:19], s40 offen sc1
    s_add_u32 s40, s44, 57344
    buffer_load_dwordx4 v[232:235], v13, s[16:19], s40 offen sc1
    s_add_u32 s40, s44, 61440
    buffer_load_dwordx4 v[236:239], v13, s[16:19], s40 offen sc1
    s_waitcnt vmcnt(15)
    v_mfma_f32_16x16x32_bf16 v[24:27], v[240:243], v[176:179], 0
    v_mfma_f32_16x16x32_bf16 v[28:31], v[244:247], v[176:179], 0
    s_waitcnt vmcnt(14)
    v_mfma_f32_16x16x32_bf16 v[24:27], v[240:243], v[180:183], v[24:27]
    v_mfma_f32_16x16x32_bf16 v[28:31], v[244:247], v[180:183], v[28:31]
    s_waitcnt vmcnt(13)
    v_mfma_f32_16x16x32_bf16 v[24:27], v[240:243], v[184:187], v[24:27]
    v_mfma_f32_16x16x32_bf16 v[28:31], v[244:247], v[184:187], v[28:31]
    s_waitcnt vmcnt(12)
    v_mfma_f32_16x16x32_bf16 v[24:27], v[240:243], v[188:191], v[24:27]
    v_mfma_f32_16x16x32_bf16 v[28:31], v[244:247], v[188:191], v[28:31]
    s_waitcnt vmcnt(11)
    v_mfma_f32_16x16x32_bf16 v[24:27], v[240:243], v[192:195], v[24:27]
    v_mfma_f32_16x16x32_bf16 v[28:31], v[244:247], v[192:195], v[28:31]
    s_waitcnt vmcnt(10)
    v_mfma_f32_16x16x32_bf16 v[24:27], v[240:243], v[196:199], v[24:27]
    v_mfma_f32_16x16x32_bf16 v[28:31], v[244:247], v[196:199], v[28:31]
    s_waitcnt vmcnt(9)
    v_mfma_f32_16x16x32_bf16 v[24:27], v[240:243], v[200:203], v[24:27]
    v_mfma_f32_16x16x32_bf16 v[28:31], v[244:247], v[200:203], v[28:31]
    s_waitcnt vmcnt(8)
    v_mfma_f32_16x16x32_bf16 v[24:27], v[240:243], v[204:207], v[24:27]
    v_mfma_f32_16x16x32_bf16 v[28:31], v[244:247], v[204:207], v[28:31]
    s_waitcnt vmcnt(7)
    v_mfma_f32_16x16x32_bf16 v[24:27], v[240:243], v[208:211], v[24:27]
    v_mfma_f32_16x16x32_bf16 v[28:31], v[244:247], v[208:211], v[28:31]
    s_waitcnt vmcnt(6)
    v_mfma_f32_16x16x32_bf16 v[24:27], v[240:243], v[212:215], v[24:27]
    v_mfma_f32_16x16x32_bf16 v[28:31], v[244:247], v[212:215], v[28:31]
    s_waitcnt vmcnt(5)
    v_mfma_f32_16x16x32_bf16 v[24:27], v[240:243], v[216:219], v[24:27]
    v_mfma_f32_16x16x32_bf16 v[28:31], v[244:247], v[216:219], v[28:31]
    s_waitcnt vmcnt(4)
    v_mfma_f32_16x16x32_bf16 v[24:27], v[240:243], v[220:223], v[24:27]
    v_mfma_f32_16x16x32_bf16 v[28:31], v[244:247], v[220:223], v[28:31]
    s_waitcnt vmcnt(3)
    v_mfma_f32_16x16x32_bf16 v[24:27], v[240:243], v[224:227], v[24:27]
    v_mfma_f32_16x16x32_bf16 v[28:31], v[244:247], v[224:227], v[28:31]
    s_waitcnt vmcnt(2)
    v_mfma_f32_16x16x32_bf16 v[24:27], v[240:243], v[228:231], v[24:27]
    v_mfma_f32_16x16x32_bf16 v[28:31], v[244:247], v[228:231], v[28:31]
    s_waitcnt vmcnt(1)
    v_mfma_f32_16x16x32_bf16 v[24:27], v[240:243], v[232:235], v[24:27]
    v_mfma_f32_16x16x32_bf16 v[28:31], v[244:247], v[232:235], v[28:31]
    s_waitcnt vmcnt(0)
    v_mfma_f32_16x16x32_bf16 v[24:27], v[240:243], v[236:239], v[24:27]
    v_mfma_f32_16x16x32_bf16 v[28:31], v[244:247], v[236:239], v[28:31]
    s_nop 7
    v_cmp_u_f32 vcc, v24, v28
    s_cmp_ge_u32 s52, 4000
    s_nop 3
    s_cbranch_scc1 L_B_ex1_done
    s_cbranch_vccnz L_B_ex1_again
L_B_ex1_done:
    v_cvt_pk_bf16_f32 v32, v24, v25
    v_cvt_pk_bf16_f32 v33, v26, v27
    v_cvt_pk_bf16_f32 v34, v28, v29
    v_cvt_pk_bf16_f32 v35, v30, v31
    v_cmp_gt_u32 vcc, 240, v0
    s_add_u32 s44, s34, 20480
    s_and_saveexec_b64 s[60:61], vcc
    ds_write_b64 v14, v[32:33]
    ds_write_b64 v1, v[34:35]
    s_mov_b64 exec, s[60:61]
    s_waitcnt lgkmcnt(0)
    s_barrier
    ds_read_b64_tr_b16 v[184:185], v11 offset:768
    ds_read_b64_tr_b16 v[194:195], v11 offset:776
    ds_read_b64_tr_b16 v[204:205], v11 offset:784
    ds_read_b64_tr_b16 v[176:177], v11 offset:0
    ds_read_b64_tr_b16 v[186:187], v11 offset:8
    ds_read_b64_tr_b16 v[196:197], v11 offset:16
    ds_read_b64_tr_b16 v[178:179], v11 offset:192
    ds_read_b64_tr_b16 v[188:189], v11 offset:200
    ds_read_b64_tr_b16 v[198:199], v11 offset:208
    ds_read_b64_tr_b16 v[180:181], v11 offset:384
    ds_read_b64_tr_b16 v[190:191], v11 offset:392
    ds_read_b64_tr_b16 v[200:201], v11 offset:400
    ds_read_b64_tr_b16 v[182:183], v11 offset:576
    ds_read_b64_tr_b16 v[192:193], v11 offset:584
    ds_read_b64_tr_b16 v[202:203], v11 offset:592
    s_waitcnt lgkmcnt(12)
    v_mfma_f32_16x16x16_bf16 v[208:211], v[184:185], v[64:65], 0
    v_mfma_f32_16x16x16_bf16 v[212:215], v[194:195], v[64:65], 0
    v_mfma_f32_16x16x16_bf16 v[216:219], v[204:205], v[64:65], 0
    v_mfma_f32_16x16x16_bf16 v[220:223], v[184:185], v[74:75], 0
    v_mfma_f32_16x16x16_bf16 v[224:227], v[194:195], v[74:75], 0
    v_mfma_f32_16x16x16_bf16 v[228:231], v[204:205], v[74:75], 0
    s_waitcnt lgkmcnt(6)
    s_nop 1
    v_mfma_f32_16x16x32_bf16 v[216:219], v[196:199], v[56:59], v[216:219]
    v_mfma_f32_16x16x32_bf16 v[208:211], v[176:179], v[56:59], v[208:211]
    v_mfma_f32_16x16x32_bf16 v[212:215], v[186:189], v[56:59], v[212:215]
    s_waitcnt lgkmcnt(0)
    v_mfma_f32_16x16x32_bf16 v[216:219], v[200:203], v[60:63], v[216:219]
    v_mfma_f32_16x16x32_bf16 v[208:211], v[180:183], v[60:63], v[208:211]
    v_mfma_f32_16x16x32_bf16 v[212:215], v[190:193], v[60:63], v[212:215]
    v_mfma_f32_16x16x32_bf16 v[228:231], v[196:199], v[66:69], v[228:231]
    v_mfma_f32_16x16x32_bf16 v[220:223], v[176:179], v[66:69], v[220:223]
    v_mfma_f32_16x16x32_bf16 v[224:227], v[186:189], v[66:69], v[224:227]
    v_mfma_f32_16x16x32_bf16 v[228:231], v[200:203], v[70:73], v[228:231]
    v_mfma_f32_16x16x32_bf16 v[220:223], v[180:183], v[70:73], v[220:223]
    v_mfma_f32_16x16x32_bf16 v[224:227], v[190:193], v[70:73], v[224:227]
    v_mov_b32 v1, v216
    v_mov_b32 v13, v216
    s_nop 1
    v_permlane16_swap_b32 v1, v13
    v_add_f32 v13, 0x358637bd, v13
    v_rcp_f32 v13, v13
    s_nop 0
    v_mul_f32 v208, v13, v208
    v_mul_f32 v209, v13, v209
    v_mul_f32 v210, v13, v210
    v_mul_f32 v211, v13, v211
    v_mul_f32 v212, v13, v212
    v_mul_f32 v213, v13, v213
    v_mul_f32 v214, v13, v214
    v_mul_f32 v215, v13, v215
    v_mul_f32 v216, v13, v216
    v_mul_f32 v217, v13, v217
    v_mul_f32 v218, v13, v218
    v_mul_f32 v219, v13, v219
    v_cvt_pk_bf16_f32 v232, v208, v209
    v_cvt_pk_bf16_f32 v233, v210, v211
    v_cvt_pk_bf16_f32 v234, v212, v213
    v_cvt_pk_bf16_f32 v235, v214, v215
    buffer_store_dwordx4 v[232:235], v2, s[16:19], s33 offen sc1
    v_cvt_pk_bf16_f32 v240, v216, v217
    v_cvt_pk_bf16_f32 v241, v218, v219
    v_mov_b32 v14, v228
    v_mov_b32 v12, v228
    s_nop 1
    v_permlane16_swap_b32 v14, v12
    v_add_f32 v12, 0x358637bd, v12
    v_rcp_f32 v12, v12
    s_nop 0
    v_mul_f32 v220, v12, v220
    v_mul_f32 v221, v12, v221
    v_mul_f32 v222, v12, v222
    v_mul_f32 v223, v12, v223
    v_mul_f32 v224, v12, v224
    v_mul_f32 v225, v12, v225
    v_mul_f32 v226, v12, v226
    v_mul_f32 v227, v12, v227
    v_mul_f32 v228, v12, v228
    v_mul_f32 v229, v12, v229
    v_mul_f32 v230, v12, v230
    v_mul_f32 v231, v12, v231
    v_cvt_pk_bf16_f32 v236, v220, v221
    v_cvt_pk_bf16_f32 v237, v222, v223
    v_cvt_pk_bf16_f32 v238, v224, v225
    v_cvt_pk_bf16_f32 v239, v226, v227
    buffer_store_dwordx4 v[236:239], v2, s[16:19], s43 offen sc1
    v_cvt_pk_bf16_f32 v242, v228, v229
    v_cvt_pk_bf16_f32 v243, v230, v231
    s_nop 0
    v_permlane32_swap_b32 v240, v242
    v_permlane32_swap_b32 v241, v243
    v_mov_b32 v1, s62
    buffer_store_dwordx4 v[240:243], v10, s[16:19], s34 offen sc1
    buffer_store_dword v1, v15, s[16:19], s38 offen sc1
    s_add_u32 m0, s46, 0
    s_mov_b32 exec_hi, 0x3ffff
    s_mul_i32 s45, s30, 204800
    buffer_load_dwordx4 v9, s[24:27], s45 offen lds
    s_mov_b32 exec_hi, -1
    s_add_u32 m0, s46, 3200
    s_mov_b32 exec_hi, 0x3ffff
    s_add_u32 s45, s45, 25600
    buffer_load_dwordx4 v9, s[24:27], s45 offen lds
    s_mov_b32 exec_hi, -1
    s_add_u32 m0, s46, 6400
    s_mov_b32 exec_hi, 0x3ffff
    s_add_u32 s45, s45, 25600
    buffer_load_dwordx4 v9, s[24:27], s45 offen lds
    s_mov_b32 exec_hi, -1
    s_add_u32 m0, s46, 9600
    s_mov_b32 exec_hi, 0x3ffff
    s_add_u32 s45, s45, 25600
    buffer_load_dwordx4 v9, s[24:27], s45 offen lds
    s_mov_b32 exec_hi, -1
    s_add_u32 m0, s46, 12800
    s_mov_b32 exec_hi, 0x3ffff
    s_add_u32 s45, s45, 25600
    buffer_load_dwordx4 v9, s[24:27], s45 offen lds
    s_mov_b32 exec_hi, -1
    s_add_u32 m0, s46, 16000
    s_mov_b32 exec_hi, 0x3ffff
    s_add_u32 s45, s45, 25600
    buffer_load_dwordx4 v9, s[24:27], s45 offen lds
    s_mov_b32 exec_hi, -1
    s_add_u32 m0, s46, 19200
    s_mov_b32 exec_hi, 0x3ffff
    s_add_u32 s45, s45, 25600
    buffer_load_dwordx4 v9, s[24:27], s45 offen lds
    s_mov_b32 exec_hi, -1
    s_add_u32 m0, s46, 22400
    s_mov_b32 exec_hi, 0x3ffff
    s_add_u32 s45, s45, 25600
    buffer_load_dwordx4 v9, s[24:27], s45 offen lds
    s_mov_b32 exec_hi, -1
    s_cmp_lg_u32 s49, 0
    s_cbranch_scc1 L_B_w0ok
    ds_read_b64_tr_b16 v[76:77], v5 offset:0
    ds_read_b64_tr_b16 v[78:79], v5 offset:640
    ds_read_b64_tr_b16 v[80:81], v5 offset:8
    ds_read_b64_tr_b16 v[82:83], v5 offset:648
    ds_read_b64_tr_b16 v[84:85], v5 offset:16
    ds_read_b64_tr_b16 v[86:87], v5 offset:656
    ds_read_b64_tr_b16 v[88:89], v5 offset:24
    ds_read_b64_tr_b16 v[90:91], v5 offset:664
    ds_read_b64_tr_b16 v[92:93], v5 offset:32
    ds_read_b64_tr_b16 v[94:95], v5 offset:672
    ds_read_b64_tr_b16 v[96:97], v5 offset:6400
    ds_read_b64_tr_b16 v[98:99], v5 offset:7040
    ds_read_b64_tr_b16 v[100:101], v5 offset:6408
    ds_read_b64_tr_b16 v[102:103], v5 offset:7048
    ds_read_b64_tr_b16 v[104:105], v5 offset:6416
    ds_read_b64_tr_b16 v[106:107], v5 offset:7056
    ds_read_b64_tr_b16 v[108:109], v5 offset:6424
    ds_read_b64_tr_b16 v[110:111], v5 offset:7064
    ds_read_b64_tr_b16 v[112:113], v5 offset:6432
    ds_read_b64_tr_b16 v[114:115], v5 offset:7072
    ds_read_b64_tr_b16 v[116:117], v5 offset:12800
    ds_read_b64_tr_b16 v[118:119], v5 offset:13440
    ds_read_b64_tr_b16 v[120:121], v5 offset:12808
    ds_read_b64_tr_b16 v[122:123], v5 offset:13448
    ds_read_b64_tr_b16 v[124:125], v5 offset:12816
    ds_read_b64_tr_b16 v[126:127], v5 offset:13456
    ds_read_b64_tr_b16 v[128:129], v5 offset:12824
    ds_read_b64_tr_b16 v[130:131], v5 offset:13464
    ds_read_b64_tr_b16 v[132:133], v5 offset:12832
    ds_read_b64_tr_b16 v[134:135], v5 offset:13472
    ds_read_b64_tr_b16 v[136:137], v5 offset:19200
    ds_read_b64_tr_b16 v[138:139], v5 offset:19840
    ds_read_b64_tr_b16 v[140:141], v5 offset:19208
    ds_read_b64_tr_b16 v[142:143], v5 offset:19848
    ds_read_b64_tr_b16 v[144:145], v5 offset:19216
    ds_read_b64_tr_b16 v[146:147], v5 offset:19856
    ds_read_b64_tr_b16 v[148:149], v5 offset:19224
    ds_read_b64_tr_b16 v[150:151], v5 offset:19864
    ds_read_b64_tr_b16 v[152:153], v5 offset:19232
    ds_read_b64_tr_b16 v[154:155], v5 offset:19872
    ds_read_b64_tr_b16 v[156:157], v6 offset:0
    ds_read_b64_tr_b16 v[158:159], v6 offset:3200
    ds_read_b64_tr_b16 v[160:161], v6 offset:8
    ds_read_b64_tr_b16 v[162:163], v6 offset:3208
    ds_read_b64_tr_b16 v[164:165], v6 offset:16
    ds_read_b64_tr_b16 v[166:167], v6 offset:3216
    ds_read_b64_tr_b16 v[168:169], v6 offset:24
    ds_read_b64_tr_b16 v[170:171], v6 offset:3224
    ds_read_b64_tr_b16 v[172:173], v6 offset:32
    ds_read_b64_tr_b16 v[174:175], v6 offset:3232
L_B_w0ok:
    s_waitcnt lgkmcnt(0)
    s_barrier
    s_add_u32 m0, s46, 25600
    s_mov_b32 exec_hi, 0x3ffff
    s_mul_i32 s45, s31, 204800
    buffer_load_dwordx4 v9, s[24:27], s45 offen lds
    s_mov_b32 exec_hi, -1
    s_add_u32 m0, s46, 28800
    s_mov_b32 exec_hi, 0x3ffff
    s_add_u32 s45, s45, 25600
    buffer_load_dwordx4 v9, s[24:27], s45 offen lds
    s_mov_b32 exec_hi, -1
    s_add_u32 m0, s46, 32000
    s_mov_b32 exec_hi, 0x3ffff
    s_add_u32 s45, s45, 25600
    buffer_load_dwordx4 v9, s[24:27], s45 offen lds
    s_mov_b32 exec_hi, -1
    s_add_u32 m0, s46, 35200
    s_mov_b32 exec_hi, 0x3ffff
    s_add_u32 s45, s45, 25600
    buffer_load_dwordx4 v9, s[24:27], s45 offen lds
    s_mov_b32 exec_hi, -1
    s_add_u32 m0, s46, 38400
    s_mov_b32 exec_hi, 0x3ffff
    s_add_u32 s45, s45, 25600
    buffer_load_dwordx4 v9, s[24:27], s45 offen lds
    s_mov_b32 exec_hi, -1
    s_add_u32 m0, s46, 41600
    s_mov_b32 exec_hi, 0x3ffff
    s_add_u32 s45, s45, 25600
    buffer_load_dwordx4 v9, s[24:27], s45 offen lds
    s_mov_b32 exec_hi, -1
    s_add_u32 m0, s46, 44800
    s_mov_b32 exec_hi, 0x3ffff
    s_add_u32 s45, s45, 25600
    buffer_load_dwordx4 v9, s[24:27], s45 offen lds
    s_mov_b32 exec_hi, -1
    s_add_u32 m0, s46, 48000
    s_mov_b32 exec_hi, 0x3ffff
    s_add_u32 s45, s45, 25600
    buffer_load_dwordx4 v9, s[24:27], s45 offen lds
    s_mov_b32 exec_hi, -1
    s_mov_b64 exec, 0xffff
    buffer_load_dword v14, v8, s[16:19], 0 offen sc1
    s_mov_b64 exec, -1
    ds_read_b64_tr_b16 v[176:177], v5 offset:25600
    ds_read_b64_tr_b16 v[178:179], v5 offset:26240
    ds_read_b64_tr_b16 v[180:181], v5 offset:25608
    ds_read_b64_tr_b16 v[182:183], v5 offset:26248
    ds_read_b64_tr_b16 v[184:185], v5 offset:25616
    ds_read_b64_tr_b16 v[186:187], v5 offset:26256
    ds_read_b64_tr_b16 v[188:189], v5 offset:25624
    ds_read_b64_tr_b16 v[190:191], v5 offset:26264
    ds_read_b64_tr_b16 v[192:193], v5 offset:25632
    ds_read_b64_tr_b16 v[194:195], v5 offset:26272
    ds_read_b64_tr_b16 v[196:197], v5 offset:32000
    ds_read_b64_tr_b16 v[198:199], v5 offset:32640
    ds_read_b64_tr_b16 v[200:201], v5 offset:32008
    ds_read_b64_tr_b16 v[202:203], v5 offset:32648
    ds_read_b64_tr_b16 v[204:205], v5 offset:32016
    ds_read_b64_tr_b16 v[206:207], v5 offset:32656
    ds_read_b64_tr_b16 v[208:209], v5 offset:32024
    ds_read_b64_tr_b16 v[210:211], v5 offset:32664
    ds_read_b64_tr_b16 v[212:213], v5 offset:32032
    ds_read_b64_tr_b16 v[214:215], v5 offset:32672
    ds_read_b64_tr_b16 v[216:217], v5 offset:38400
    ds_read_b64_tr_b16 v[218:219], v5 offset:39040
    ds_read_b64_tr_b16 v[220:221], v5 offset:38408
    ds_read_b64_tr_b16 v[222:223], v5 offset:39048
    ds_read_b64_tr_b16 v[224:225], v5 offset:38416
    ds_read_b64_tr_b16 v[226:227], v5 offset:39056
    ds_read_b64_tr_b16 v[228:229], v5 offset:38424
    ds_read_b64_tr_b16 v[230:231], v5 offset:39064
    ds_read_b64_tr_b16 v[232:233], v5 offset:38432
    ds_read_b64_tr_b16 v[234:235], v5 offset:39072
    ds_read_b64_tr_b16 v[236:237], v5 offset:44800
    ds_read_b64_tr_b16 v[238:239], v5 offset:45440
    ds_read_b64_tr_b16 v[240:241], v5 offset:44808
    ds_read_b64_tr_b16 v[242:243], v5 offset:45448
    ds_read_b64_tr_b16 v[244:245], v5 offset:44816
    ds_read_b64_tr_b16 v[246:247], v5 offset:45456
    ds_read_b64_tr_b16 v[248:249], v5 offset:44824
    ds_read_b64_tr_b16 v[250:251], v5 offset:45464
    ds_read_b64_tr_b16 v[252:253], v5 offset:44832
    ds_read_b64_tr_b16 v[254:255], v5 offset:45472
    s_mov_b32 s52, 0
    s_waitcnt vmcnt(0)
    s_branch L_B_ex2c
L_B_ex2:
    s_waitcnt vmcnt(0)
L_B_ex2c:
    v_cmp_ne_u32 vcc, s62, v14
    s_add_u32 s52, s52, 1
    s_and_b32 s54, vcc_lo, 0xffff
    s_nop 2
    s_cbranch_scc0 L_B_go
    s_cmp_ge_u32 s52, 4000
    s_cbranch_scc1 L_B_go
    s_mov_b64 exec, 0xffff
    buffer_load_dword v14, v8, s[16:19], 0 offen sc1
    s_mov_b64 exec, -1
    s_branch L_B_ex2
L_B_go:
    s_lshl_b32 s40, s28, 12
    s_add_u32 s40, s40, s3
    buffer_load_dwordx4 v[36:39], v2, s[16:19], s40 offen sc1
    buffer_load_dwordx4 v[40:43], v2, s[16:19], s40 offen offset:1024 sc1
    buffer_load_dwordx4 v[44:47], v2, s[16:19], s40 offen offset:2048 sc1
    buffer_load_dwordx4 v[48:51], v2, s[16:19], s40 offen offset:3072 sc1
    s_lshl_b32 s42, s28, 10
    s_add_u32 s42, s42, s41
    buffer_load_dwordx4 v[52:55], v2, s[16:19], s42 offen sc1
    s_lshl_b32 s40, s29, 12
    s_add_u32 s40, s40, s3
    buffer_load_dwordx4 v[56:59], v2, s[16:19], s40 offen sc1
    buffer_load_dwordx4 v[60:63], v2, s[16:19], s40 offen offset:1024 sc1
    buffer_load_dwordx4 v[64:67], v2, s[16:19], s40 offen offset:2048 sc1
    buffer_load_dwordx4 v[68:71], v2, s[16:19], s40 offen offset:3072 sc1
    s_lshl_b32 s42, s29, 10
    s_add_u32 s42, s42, s41
    buffer_load_dwordx4 v[72:75], v2, s[16:19], s42 offen sc1
    v_and_b32 v1, 63, v0
    v_and_b32 v12, 15, v0
    v_mul_u32_u24 v10, 160, v12
    v_bfe_u32 v13, v0, 4, 2
    v_mul_u32_u24 v13, 40, v13
    s_mul_i32 s43, s39, 2560
    s_add_u32 s43, s43, 51200
    v_add3_u32 v10, v10, v13, s43
    v_add_u32 v11, s43, v2
    v_readfirstlane_b32 s44, v7
    v_add_u32 v12, 0, v1
    v_mul_u32_u24 v13, 6554, v12
    v_lshrrev_b32 v13, 16, v13
    v_mul_u32_u24 v13, 2400, v13
    v_lshl_add_u32 v13, v12, 4, v13
    v_add_u32 v7, s44, v13
    v_add_u32 v12, 64, v1
    v_mul_u32_u24 v13, 6554, v12
    v_lshrrev_b32 v13, 16, v13
    v_mul_u32_u24 v13, 2400, v13
    v_lshl_add_u32 v13, v12, 4, v13
    v_add_u32 v8, s44, v13
    v_add_u32 v12, 128, v1
    v_mul_u32_u24 v13, 6554, v12
    v_lshrrev_b32 v13, 16, v13
    v_mul_u32_u24 v13, 2400, v13
    v_lshl_add_u32 v13, v12, 4, v13
    v_add_u32 v9, s44, v13
    v_mov_b32 v12, 1073741824
    v_cmp_gt_u32 vcc, 32, v1
    s_nop 1
    v_cndmask_b32 v9, v12, v9, vcc
    s_waitcnt lgkmcnt(0)
    s_waitcnt vmcnt(9)
    v_max3_u32 v13, v36, v37, v38
    v_max_u32 v13, v13, v39
    v_cmp_eq_u32 vcc, -1, v13
    s_nop 4
    s_cbranch_vccnz L_B_fix0
L_B_ok0:
    v_mfma_f32_16x16x32_bf16 v[16:19], v[76:79], v[36:39], 0
    s_waitcnt vmcnt(8)
    v_max3_u32 v13, v40, v41, v42
    v_mfma_f32_16x16x32_bf16 v[20:23], v[80:83], v[36:39], 0
    v_max_u32 v13, v13, v43
    v_cmp_eq_u32 vcc, -1, v13
    v_mfma_f32_16x16x32_bf16 v[24:27], v[84:87], v[36:39], 0
    v_mfma_f32_16x16x32_bf16 v[28:31], v[88:91], v[36:39], 0
    v_mfma_f32_16x16x32_bf16 v[32:35], v[92:95], v[36:39], 0
    s_lshl_b32 s40, s30, 12
    s_add_u32 s40, s40, s3
    buffer_load_dwordx4 v[36:39], v2, s[16:19], s40 offen sc1
    s_cbranch_vccnz L_B_fix1
L_B_ok1:
    v_mfma_f32_16x16x32_bf16 v[16:19], v[96:99], v[40:43], v[16:19]
    s_waitcnt vmcnt(8)
    v_max3_u32 v13, v44, v45, v46
    v_mfma_f32_16x16x32_bf16 v[20:23], v[100:103], v[40:43], v[20:23]
    v_max_u32 v13, v13, v47
    v_cmp_eq_u32 vcc, -1, v13
    v_mfma_f32_16x16x32_bf16 v[24:27], v[104:107], v[40:43], v[24:27]
    ds_read_b64_tr_b16 v[76:77], v6 offset:25600
    ds_read_b64_tr_b16 v[78:79], v6 offset:28800
    v_mfma_f32_16x16x32_bf16 v[28:31], v[108:111], v[40:43], v[28:31]
    ds_read_b64_tr_b16 v[80:81], v6 offset:25608
    ds_read_b64_tr_b16 v[82:83], v6 offset:28808
    v_mfma_f32_16x16x32_bf16 v[32:35], v[112:115], v[40:43], v[32:35]
    ds_read_b64_tr_b16 v[84:85], v6 offset:25616
    ds_read_b64_tr_b16 v[86:87], v6 offset:28816
    ds_read_b64_tr_b16 v[88:89], v6 offset:25624
    buffer_load_dwordx4 v[40:43], v2, s[16:19], s40 offen offset:1024 sc1
    s_cbranch_vccnz L_B_fix2
L_B_ok2:
    s_barrier
    v_mfma_f32_16x16x32_bf16 v[16:19], v[116:119], v[44:47], v[16:19]
    s_waitcnt vmcnt(8)
    v_max3_u32 v13, v48, v49, v50
    v_mfma_f32_16x16x32_bf16 v[20:23], v[120:123], v[44:47], v[20:23]
    v_max_u32 v13, v13, v51
    v_cmp_eq_u32 vcc, -1, v13
    v_mfma_f32_16x16x32_bf16 v[24:27], v[124:127], v[44:47], v[24:27]
    ds_read_b64_tr_b16 v[90:91], v6 offset:28824
    ds_read_b64_tr_b16 v[92:93], v6 offset:25632
    v_mfma_f32_16x16x32_bf16 v[28:31], v[128:131], v[44:47], v[28:31]
    ds_read_b64_tr_b16 v[94:95], v6 offset:28832
    ds_read_b64_tr_b16 v[96:97], v3 offset:0
    v_mfma_f32_16x16x32_bf16 v[32:35], v[132:135], v[44:47], v[32:35]
    ds_read_b64_tr_b16 v[98:99], v3 offset:640
    ds_read_b64_tr_b16 v[100:101], v3 offset:8
    ds_read_b64_tr_b16 v[102:103], v3 offset:648
    buffer_load_dwordx4 v[44:47], v2, s[16:19], s40 offen offset:2048 sc1
    s_cbranch_vccnz L_B_fix3
L_B_ok3:
    v_mfma_f32_16x16x32_bf16 v[16:19], v[136:139], v[48:51], v[16:19]
    s_waitcnt vmcnt(8)
    v_max3_u32 v13, v52, v53, v54
    v_mfma_f32_16x16x32_bf16 v[20:23], v[140:143], v[48:51], v[20:23]
    v_max_u32 v13, v13, v55
    v_cmp_eq_u32 vcc, -1, v13
    v_mfma_f32_16x16x32_bf16 v[24:27], v[144:147], v[48:51], v[24:27]
    ds_read_b64_tr_b16 v[104:105], v3 offset:16
    ds_read_b64_tr_b16 v[106:107], v3 offset:656
    v_mfma_f32_16x16x32_bf16 v[28:31], v[148:151], v[48:51], v[28:31]
    ds_read_b64_tr_b16 v[108:109], v3 offset:24
    ds_read_b64_tr_b16 v[110:111], v3 offset:664
    v_mfma_f32_16x16x32_bf16 v[32:35], v[152:155], v[48:51], v[32:35]
    ds_read_b64_tr_b16 v[112:113], v3 offset:32
    ds_read_b64_tr_b16 v[114:115], v3 offset:672
    ds_read_b64_tr_b16 v[116:117], v3 offset:6400
    buffer_load_dwordx4 v[48:51], v2, s[16:19], s40 offen offset:3072 sc1
    s_cbranch_vccnz L_B_fix4
L_B_ok4:
    v_mfma_f32_16x16x32_bf16 v[16:19], v[156:159], v[52:55], v[16:19]
    s_waitcnt vmcnt(8)
    v_max3_u32 v13, v56, v57, v58
    v_mfma_f32_16x16x32_bf16 v[20:23], v[160:163], v[52:55], v[20:23]
    v_max_u32 v13, v13, v59
    v_cmp_eq_u32 vcc, -1, v13
    v_mfma_f32_16x16x32_bf16 v[24:27], v[164:167], v[52:55], v[24:27]
    ds_read_b64_tr_b16 v[118:119], v3 offset:7040
    ds_read_b64_tr_b16 v[120:121], v3 offset:6408
    v_mfma_f32_16x16x32_bf16 v[28:31], v[168:171], v[52:55], v[28:31]
    ds_read_b64_tr_b16 v[122:123], v3 offset:7048
    ds_read_b64_tr_b16 v[124:125], v3 offset:6416
    v_mfma_f32_16x16x32_bf16 v[32:35], v[172:175], v[52:55], v[32:35]
    ds_read_b64_tr_b16 v[126:127], v3 offset:7056
    ds_read_b64_tr_b16 v[128:129], v3 offset:6424
    ds_read_b64_tr_b16 v[130:131], v3 offset:7064
    s_lshl_b32 s42, s30, 10
    s_add_u32 s42, s42, s41
    buffer_load_dwordx4 v[52:55], v2, s[16:19], s42 offen sc1
    s_cbranch_vccnz L_B_fix5
L_B_ok5:
    v_mfma_f32_16x16x32_bf16 v[16:19], v[176:179], v[56:59], v[16:19]
    s_waitcnt vmcnt(8)
    v_max3_u32 v13, v60, v61, v62
    v_mfma_f32_16x16x32_bf16 v[20:23], v[180:183], v[56:59], v[20:23]
    v_max_u32 v13, v13, v63
    v_cmp_eq_u32 vcc, -1, v13
    v_mfma_f32_16x16x32_bf16 v[24:27], v[184:187], v[56:59], v[24:27]
    ds_read_b64_tr_b16 v[132:133], v3 offset:6432
    ds_read_b64_tr_b16 v[134:135], v3 offset:7072
    v_mfma_f32_16x16x32_bf16 v[28:31], v[188:191], v[56:59], v[28:31]
    ds_read_b64_tr_b16 v[136:137], v3 offset:12800
    ds_read_b64_tr_b16 v[138:139], v3 offset:13440
    v_mfma_f32_16x16x32_bf16 v[32:35], v[192:195], v[56:59], v[32:35]
    ds_read_b64_tr_b16 v[140:141], v3 offset:12808
    ds_read_b64_tr_b16 v[142:143], v3 offset:13448
    ds_read_b64_tr_b16 v[144:145], v3 offset:12816
    s_lshl_b32 s40, s31, 12
    s_add_u32 s40, s40, s3
    buffer_load_dwordx4 v[56:59], v2, s[16:19], s40 offen sc1
    s_cbranch_vccnz L_B_fix6
L_B_ok6:
    v_mfma_f32_16x16x32_bf16 v[16:19], v[196:199], v[60:63], v[16:19]
    s_waitcnt vmcnt(8)
    v_max3_u32 v13, v64, v65, v66
    v_mfma_f32_16x16x32_bf16 v[20:23], v[200:203], v[60:63], v[20:23]
    v_max_u32 v13, v13, v67
    v_cmp_eq_u32 vcc, -1, v13
    v_mfma_f32_16x16x32_bf16 v[24:27], v[204:207], v[60:63], v[24:27]
    ds_read_b64_tr_b16 v[146:147], v3 offset:13456
    ds_read_b64_tr_b16 v[148:149], v3 offset:12824
    v_mfma_f32_16x16x32_bf16 v[28:31], v[208:211], v[60:63], v[28:31]
    ds_read_b64_tr_b16 v[150:151], v3 offset:13464
    ds_read_b64_tr_b16 v[152:153], v3 offset:12832
    v_mfma_f32_16x16x32_bf16 v[32:35], v[212:215], v[60:63], v[32:35]
    ds_read_b64_tr_b16 v[154:155], v3 offset:13472
    ds_read_b64_tr_b16 v[156:157], v3 offset:19200
    ds_read_b64_tr_b16 v[158:159], v3 offset:19840
    buffer_load_dwordx4 v[60:63], v2, s[16:19], s40 offen offset:1024 sc1
    s_cbranch_vccnz L_B_fix7
L_B_ok7:
    v_mfma_f32_16x16x32_bf16 v[16:19], v[216:219], v[64:67], v[16:19]
    s_waitcnt vmcnt(8)
    v_max3_u32 v13, v68, v69, v70
    v_mfma_f32_16x16x32_bf16 v[20:23], v[220:223], v[64:67], v[20:23]
    v_max_u32 v13, v13, v71
    v_cmp_eq_u32 vcc, -1, v13
    v_mfma_f32_16x16x32_bf16 v[24:27], v[224:227], v[64:67], v[24:27]
    ds_read_b64_tr_b16 v[160:161], v3 offset:19208
    ds_read_b64_tr_b16 v[162:163], v3 offset:19848
    v_mfma_f32_16x16x32_bf16 v[28:31], v[228:231], v[64:67], v[28:31]
    ds_read_b64_tr_b16 v[164:165], v3 offset:19216
    ds_read_b64_tr_b16 v[166:167], v3 offset:19856
    v_mfma_f32_16x16x32_bf16 v[32:35], v[232:235], v[64:67], v[32:35]
    ds_read_b64_tr_b16 v[168:169], v3 offset:19224
    ds_read_b64_tr_b16 v[170:171], v3 offset:19864
    ds_read_b64_tr_b16 v[172:173], v3 offset:19232
    buffer_load_dwordx4 v[64:67], v2, s[16:19], s40 offen offset:2048 sc1
    s_cbranch_vccnz L_B_fix8
L_B_ok8:
    s_barrier
    v_mfma_f32_16x16x32_bf16 v[16:19], v[236:239], v[68:71], v[16:19]
    s_waitcnt vmcnt(8)
    v_max3_u32 v13, v72, v73, v74
    v_mfma_f32_16x16x32_bf16 v[20:23], v[240:243], v[68:71], v[20:23]
    v_max_u32 v13, v13, v75
    v_cmp_eq_u32 vcc, -1, v13
    v_mfma_f32_16x16x32_bf16 v[24:27], v[244:247], v[68:71], v[24:27]
    ds_read_b64_tr_b16 v[174:175], v3 offset:19872
    ds_read_b64_tr_b16 v[176:177], v4 offset:0
    v_mfma_f32_16x16x32_bf16 v[28:31], v[248:251], v[68:71], v[28:31]
    ds_read_b64_tr_b16 v[178:179], v4 offset:3200
    ds_read_b64_tr_b16 v[180:181], v4 offset:8
    v_mfma_f32_16x16x32_bf16 v[32:35], v[252:255], v[68:71], v[32:35]
    ds_read_b64_tr_b16 v[182:183], v4 offset:3208
    ds_read_b64_tr_b16 v[184:185], v4 offset:16
    ds_read_b64_tr_b16 v[186:187], v4 offset:3216
    buffer_load_dwordx4 v[68:71], v2, s[16:19], s40 offen offset:3072 sc1
    s_cbranch_vccnz L_B_fix9
L_B_ok9:
    s_waitcnt lgkmcnt(15)
    v_mfma_f32_16x16x32_bf16 v[16:19], v[76:79], v[72:75], v[16:19]
    s_waitcnt vmcnt(8)
    v_max3_u32 v13, v36, v37, v38
    v_mfma_f32_16x16x32_bf16 v[20:23], v[80:83], v[72:75], v[20:23]
    v_max_u32 v13, v13, v39
    v_cmp_eq_u32 vcc, -1, v13
    v_mfma_f32_16x16x32_bf16 v[24:27], v[84:87], v[72:75], v[24:27]
    ds_read_b64_tr_b16 v[188:189], v4 offset:24
    ds_read_b64_tr_b16 v[190:191], v4 offset:3224
    v_mfma_f32_16x16x32_bf16 v[28:31], v[88:91], v[72:75], v[28:31]
    ds_read_b64_tr_b16 v[192:193], v4 offset:32
    ds_read_b64_tr_b16 v[194:195], v4 offset:3232
    v_mfma_f32_16x16x32_bf16 v[32:35], v[92:95], v[72:75], v[32:35]
    ds_read_b64_tr_b16 v[196:197], v5 offset:0
    ds_read_b64_tr_b16 v[198:199], v5 offset:640
    ds_read_b64_tr_b16 v[200:201], v5 offset:8
    s_lshl_b32 s42, s31, 10
    s_add_u32 s42, s42, s41
    buffer_load_dwordx4 v[72:75], v2, s[16:19], s42 offen sc1
    s_cbranch_vccnz L_B_fix10
L_B_ok10:
    v_mfma_f32_16x16x32_bf16 v[16:19], v[96:99], v[36:39], v[16:19]
    s_waitcnt vmcnt(8)
    v_max3_u32 v13, v40, v41, v42
    v_mfma_f32_16x16x32_bf16 v[20:23], v[100:103], v[36:39], v[20:23]
    v_max_u32 v13, v13, v43
    v_cmp_eq_u32 vcc, -1, v13
    v_mfma_f32_16x16x32_bf16 v[24:27], v[104:107], v[36:39], v[24:27]
    ds_read_b64_tr_b16 v[202:203], v5 offset:648
    ds_read_b64_tr_b16 v[204:205], v5 offset:16
    v_mfma_f32_16x16x32_bf16 v[28:31], v[108:111], v[36:39], v[28:31]
    ds_read_b64_tr_b16 v[206:207], v5 offset:656
    ds_read_b64_tr_b16 v[208:209], v5 offset:24
    v_mfma_f32_16x16x32_bf16 v[32:35], v[112:115], v[36:39], v[32:35]
    ds_read_b64_tr_b16 v[210:211], v5 offset:664
    ds_read_b64_tr_b16 v[212:213], v5 offset:32
    ds_read_b64_tr_b16 v[214:215], v5 offset:672
    s_cbranch_vccnz L_B_fix11
L_B_ok11:
    v_mfma_f32_16x16x32_bf16 v[16:19], v[116:119], v[40:43], v[16:19]
    s_waitcnt vmcnt(7)
    v_max3_u32 v13, v44, v45, v46
    v_mfma_f32_16x16x32_bf16 v[20:23], v[120:123], v[40:43], v[20:23]
    v_max_u32 v13, v13, v47
    v_cmp_eq_u32 vcc, -1, v13
    v_mfma_f32_16x16x32_bf16 v[24:27], v[124:127], v[40:43], v[24:27]
    ds_read_b64_tr_b16 v[216:217], v5 offset:6400
    ds_read_b64_tr_b16 v[218:219], v5 offset:7040
    v_mfma_f32_16x16x32_bf16 v[28:31], v[128:131], v[40:43], v[28:31]
    ds_read_b64_tr_b16 v[220:221], v5 offset:6408
    ds_read_b64_tr_b16 v[222:223], v5 offset:7048
    v_mfma_f32_16x16x32_bf16 v[32:35], v[132:135], v[40:43], v[32:35]
    ds_read_b64_tr_b16 v[224:225], v5 offset:6416
    ds_read_b64_tr_b16 v[226:227], v5 offset:7056
    ds_read_b64_tr_b16 v[228:229], v5 offset:6424
    s_cbranch_vccnz L_B_fix12
L_B_ok12:
    v_mfma_f32_16x16x32_bf16 v[16:19], v[136:139], v[44:47], v[16:19]
    s_waitcnt vmcnt(6)
    v_max3_u32 v13, v48, v49, v50
    v_mfma_f32_16x16x32_bf16 v[20:23], v[140:143], v[44:47], v[20:23]
    v_max_u32 v13, v13, v51
    v_cmp_eq_u32 vcc, -1, v13
    v_mfma_f32_16x16x32_bf16 v[24:27], v[144:147], v[44:47], v[24:27]
    ds_read_b64_tr_b16 v[230:231], v5 offset:7064
    ds_read_b64_tr_b16 v[232:233], v5 offset:6432
    v_mfma_f32_16x16x32_bf16 v[28:31], v[148:151], v[44:47], v[28:31]
    ds_read_b64_tr_b16 v[234:235], v5 offset:7072
    ds_read_b64_tr_b16 v[236:237], v5 offset:12800
    v_mfma_f32_16x16x32_bf16 v[32:35], v[152:155], v[44:47], v[32:35]
    ds_read_b64_tr_b16 v[238:239], v5 offset:13440
    ds_read_b64_tr_b16 v[240:241], v5 offset:12808
    ds_read_b64_tr_b16 v[242:243], v5 offset:13448
    s_cbranch_vccnz L_B_fix13
L_B_ok13:
    s_waitcnt lgkmcnt(15)
    v_mfma_f32_16x16x32_bf16 v[16:19], v[156:159], v[48:51], v[16:19]
    s_waitcnt vmcnt(5)
    v_max3_u32 v13, v52, v53, v54
    v_mfma_f32_16x16x32_bf16 v[20:23], v[160:163], v[48:51], v[20:23]
    v_max_u32 v13, v13, v55
    v_cmp_eq_u32 vcc, -1, v13
    v_mfma_f32_16x16x32_bf16 v[24:27], v[164:167], v[48:51], v[24:27]
    ds_read_b64_tr_b16 v[244:245], v5 offset:12816
    ds_read_b64_tr_b16 v[246:247], v5 offset:13456
    v_mfma_f32_16x16x32_bf16 v[28:31], v[168:171], v[48:51], v[28:31]
    ds_read_b64_tr_b16 v[248:249], v5 offset:12824
    ds_read_b64_tr_b16 v[250:251], v5 offset:13464
    v_mfma_f32_16x16x32_bf16 v[32:35], v[172:175], v[48:51], v[32:35]
    ds_read_b64_tr_b16 v[252:253], v5 offset:12832
    ds_read_b64_tr_b16 v[254:255], v5 offset:13472
    ds_read_b64_tr_b16 v[76:77], v5 offset:19200
    s_cbranch_vccnz L_B_fix14
L_B_ok14:
    v_mfma_f32_16x16x32_bf16 v[16:19], v[176:179], v[52:55], v[16:19]
    s_waitcnt vmcnt(4)
    v_max3_u32 v13, v56, v57, v58
    v_mfma_f32_16x16x32_bf16 v[20:23], v[180:183], v[52:55], v[20:23]
    v_max_u32 v13, v13, v59
    v_cmp_eq_u32 vcc, -1, v13
    v_mfma_f32_16x16x32_bf16 v[24:27], v[184:187], v[52:55], v[24:27]
    ds_read_b64_tr_b16 v[78:79], v5 offset:19840
    ds_read_b64_tr_b16 v[80:81], v5 offset:19208
    v_mfma_f32_16x16x32_bf16 v[28:31], v[188:191], v[52:55], v[28:31]
    ds_read_b64_tr_b16 v[82:83], v5 offset:19848
    ds_read_b64_tr_b16 v[84:85], v5 offset:19216
    v_mfma_f32_16x16x32_bf16 v[32:35], v[192:195], v[52:55], v[32:35]
    ds_read_b64_tr_b16 v[86:87], v5 offset:19856
    ds_read_b64_tr_b16 v[88:89], v5 offset:19224
    ds_read_b64_tr_b16 v[90:91], v5 offset:19864
    s_cbranch_vccnz L_B_fix15
L_B_ok15:
    s_waitcnt lgkmcnt(15)
    v_mfma_f32_16x16x32_bf16 v[16:19], v[196:199], v[56:59], v[16:19]
    s_waitcnt vmcnt(3)
    v_max3_u32 v13, v60, v61, v62
    v_mfma_f32_16x16x32_bf16 v[20:23], v[200:203], v[56:59], v[20:23]
    v_max_u32 v13, v13, v63
    v_cmp_eq_u32 vcc, -1, v13
    v_mfma_f32_16x16x32_bf16 v[24:27], v[204:207], v[56:59], v[24:27]
    ds_read_b64_tr_b16 v[92:93], v5 offset:19232
    ds_read_b64_tr_b16 v[94:95], v5 offset:19872
    v_mfma_f32_16x16x32_bf16 v[28:31], v[208:211], v[56:59], v[28:31]
    ds_read_b64_tr_b16 v[96:97], v6 offset:0
    ds_read_b64_tr_b16 v[98:99], v6 offset:3200
    v_mfma_f32_16x16x32_bf16 v[32:35], v[212:215], v[56:59], v[32:35]
    ds_read_b64_tr_b16 v[100:101], v6 offset:8
    ds_read_b64_tr_b16 v[102:103], v6 offset:3208
    ds_read_b64_tr_b16 v[104:105], v6 offset:16
    s_cbranch_vccnz L_B_fix16
L_B_ok16:
    v_mfma_f32_16x16x32_bf16 v[16:19], v[216:219], v[60:63], v[16:19]
    s_waitcnt vmcnt(2)
    v_max3_u32 v13, v64, v65, v66
    v_mfma_f32_16x16x32_bf16 v[20:23], v[220:223], v[60:63], v[20:23]
    v_max_u32 v13, v13, v67
    v_cmp_eq_u32 vcc, -1, v13
    v_mfma_f32_16x16x32_bf16 v[24:27], v[224:227], v[60:63], v[24:27]
    ds_read_b64_tr_b16 v[106:107], v6 offset:3216
    ds_read_b64_tr_b16 v[108:109], v6 offset:24
    v_mfma_f32_16x16x32_bf16 v[28:31], v[228:231], v[60:63], v[28:31]
    ds_read_b64_tr_b16 v[110:111], v6 offset:3224
    ds_read_b64_tr_b16 v[112:113], v6 offset:32
    v_mfma_f32_16x16x32_bf16 v[32:35], v[232:235], v[60:63], v[32:35]
    ds_read_b64_tr_b16 v[114:115], v6 offset:3232
    s_cbranch_vccnz L_B_fix17
L_B_ok17:
    s_waitcnt lgkmcnt(15)
    v_mfma_f32_16x16x32_bf16 v[16:19], v[236:239], v[64:67], v[16:19]
    s_waitcnt vmcnt(1)
    v_max3_u32 v13, v68, v69, v70
    v_mfma_f32_16x16x32_bf16 v[20:23], v[240:243], v[64:67], v[20:23]
    v_max_u32 v13, v13, v71
    v_cmp_eq_u32 vcc, -1, v13
    v_mfma_f32_16x16x32_bf16 v[24:27], v[244:247], v[64:67], v[24:27]
    v_mfma_f32_16x16x32_bf16 v[28:31], v[248:251], v[64:67], v[28:31]
    v_mfma_f32_16x16x32_bf16 v[32:35], v[252:255], v[64:67], v[32:35]
    s_nop 1
    s_cbranch_vccnz L_B_fix18
L_B_ok18:
    s_waitcnt lgkmcnt(10)
    v_mfma_f32_16x16x32_bf16 v[16:19], v[76:79], v[68:71], v[16:19]
    s_waitcnt vmcnt(0)
    v_max3_u32 v13, v72, v73, v74
    v_mfma_f32_16x16x32_bf16 v[20:23], v[80:83], v[68:71], v[20:23]
    v_max_u32 v13, v13, v75
    v_cmp_eq_u32 vcc, -1, v13
    v_mfma_f32_16x16x32_bf16 v[24:27], v[84:87], v[68:71], v[24:27]
    v_mfma_f32_16x16x32_bf16 v[28:31], v[88:91], v[68:71], v[28:31]
    v_mfma_f32_16x16x32_bf16 v[32:35], v[92:95], v[68:71], v[32:35]
    s_nop 1
    s_cbranch_vccnz L_B_fix19
L_B_ok19:
    s_waitcnt lgkmcnt(0)
    v_mfma_f32_16x16x32_bf16 v[16:19], v[96:99], v[72:75], v[16:19]
    v_mfma_f32_16x16x32_bf16 v[20:23], v[100:103], v[72:75], v[20:23]
    v_mfma_f32_16x16x32_bf16 v[24:27], v[104:107], v[72:75], v[24:27]
    v_mfma_f32_16x16x32_bf16 v[28:31], v[108:111], v[72:75], v[28:31]
    v_mfma_f32_16x16x32_bf16 v[32:35], v[112:115], v[72:75], v[32:35]
    s_nop 3
    v_cvt_pk_bf16_f32 v40, v16, v17
    v_cvt_pk_bf16_f32 v41, v18, v19
    ds_write_b64 v10, v[40:41] offset:0
    v_cvt_pk_bf16_f32 v42, v20, v21
    v_cvt_pk_bf16_f32 v43, v22, v23
    ds_write_b64 v10, v[42:43] offset:8
    v_cvt_pk_bf16_f32 v44, v24, v25
    v_cvt_pk_bf16_f32 v45, v26, v27
    ds_write_b64 v10, v[44:45] offset:16
    v_cvt_pk_bf16_f32 v46, v28, v29
    v_cvt_pk_bf16_f32 v47, v30, v31
    ds_write_b64 v10, v[46:47] offset:24
    v_cvt_pk_bf16_f32 v48, v32, v33
    v_cvt_pk_bf16_f32 v49, v34, v35
    ds_write_b64 v10, v[48:49] offset:32
    ds_read_b128 v[52:55], v11 offset:0
    ds_read_b128 v[56:59], v11 offset:1024
    ds_read_b128 v[60:63], v11 offset:2048
    s_waitcnt lgkmcnt(2)
    buffer_store_dwordx4 v[52:55], v7, s[20:23], 0 offen
    s_waitcnt lgkmcnt(1)
    buffer_store_dwordx4 v[56:59], v8, s[20:23], 0 offen
    s_waitcnt lgkmcnt(0)
    buffer_store_dwordx4 v[60:63], v9, s[20:23], 0 offen
    s_cmp_lg_u32 s2, 0
    s_nop 0
    s_cbranch_scc1 L_B_fin
    v_mov_b32 v1, 1073741824
    v_cmp_eq_u32 vcc, 0, v0
    s_nop 1
    v_cndmask_b32 v1, v1, v0, vcc
    v_mov_b32 v2, s62
    s_mov_b32 s40, 7864320
    buffer_store_dword v2, v1, s[16:19], s40 offen sc1
L_B_fin:
    s_endpgm
L_A2:
    s_load_dwordx2 s[20:21], s[0:1], 104
    s_load_dwordx2 s[16:17], s[0:1], 120
    s_add_u32 s2, s2, 256
    v_lshrrev_b32 v2, 6, v0
    v_and_b32 v1, 63, v0
    v_readfirstlane_b32 s39, v2
    s_lshr_b32 s37, s36, 4
    s_and_b32 s38, s36, 15
    s_lshl_b32 s58, s36, 2
    s_add_u32 s58, s58, s39
    s_mul_i32 s59, s39, 20480
    s_mov_b32 s14, 0xffff0000
    s_mov_b32 s18, 67108864
    s_mov_b32 s19, 0x00020000
    s_mov_b32 s22, 5242880
    s_mov_b32 s23, 0x00020000
    s_lshl_b32 s34, s37, 8
    s_add_u32 s34, s34, 7864576
    v_lshlrev_b32 v7, 4, v1
    s_mul_i32 s35, s37, 262144
    s_mul_i32 s12, s39, 65536
    s_add_u32 s35, s35, s12
    s_lshl_b32 s12, s38, 10
    s_add_u32 s35, s35, s12
    s_add_u32 s35, s35, 12582912
    s_waitcnt lgkmcnt(0)
    s_add_u32 s32, s16, s34
    s_addc_u32 s33, s17, 0
    v_mov_b32 v5, 1073741824
    v_cmp_eq_u32 vcc, 0, v0
    s_nop 1
    v_cndmask_b32 v4, v5, v0, vcc
    v_lshl_add_u32 v2, v1, 3, s59
    v_and_b32 v5, 31, v1
    v_mul_u32_u24 v3, 528, v5
    v_lshrrev_b32 v5, 5, v1
    v_lshl_add_u32 v3, v5, 4, v3
    v_add_u32 v3, s59, v3
    s_waitcnt vmcnt(0)
    s_load_dword s62, s[32:33], 0
    s_setprio 1
    v_lshlrev_b32 v13, 16, v62
    s_mov_b32 s9, 0x3fb8aa3b
    s_mov_b32 s10, 0x32a57060
    v_mul_f32 v14, s9, v13
    v_fma_f32 v15, v13, s9, -v14
    v_fma_f32 v15, v13, s10, v15
    v_exp_f32 v14, v14
    v_mul_f32 v15, 0x3f317218, v15
    v_fma_f32 v14, v14, v15, v14
    v_cvt_pk_bf16_f32 v12, v14, v14
    v_and_b32 v12, s14, v12
    v_lshlrev_b32 v63, 16, v63
    v_lshlrev_b32 v64, 16, v56
    v_and_b32 v65, s14, v56
    v_lshlrev_b32 v66, 16, v57
    v_and_b32 v67, s14, v57
    v_lshlrev_b32 v68, 16, v58
    v_lshlrev_b32 v69, 16, v59
    v_and_b32 v70, s14, v58
    v_and_b32 v71, s14, v59
    v_lshlrev_b32 v72, 16, v60
    v_lshlrev_b32 v73, 16, v61
    v_and_b32 v74, s14, v60
    v_and_b32 v75, s14, v61
    v_mul_f32 v64, v12, v64
    v_mul_f32 v65, v12, v65
    v_mul_f32 v66, v12, v66
    v_mul_f32 v67, v12, v67
    v_mul_f32 v68, v12, v68
    v_mul_f32 v69, v12, v69
    v_mul_f32 v70, v12, v70
    v_mul_f32 v71, v12, v71
    v_mul_f32 v64, s9, v64
    v_mul_f32 v65, s9, v65
    v_mul_f32 v66, 0.15915494309189535, v66
    v_mul_f32 v67, 0.15915494309189535, v67
    v_mul_f32 v12, 0x3f800000, v64
    v_mul_f32 v13, 0x3f800000, v65
    v_mul_f32 v14, 0x3f800000, v66
    v_mul_f32 v15, 0x3f800000, v67
    v_exp_f32 v12, v12
    v_exp_f32 v13, v13
    v_fract_f32 v14, v14
    v_fract_f32 v15, v15
    v_cos_f32 v76, v14
    v_sin_f32 v77, v14
    v_cos_f32 v78, v15
    v_sin_f32 v79, v15
    v_mul_f32 v76, v12, v76
    v_mul_f32 v77, v12, v77
    v_mul_f32 v78, v13, v78
    v_mul_f32 v79, v13, v79
    v_mul_f32 v12, 0x41000000, v64
    v_mul_f32 v13, 0x41000000, v65
    v_mul_f32 v14, 0x41000000, v66
    v_mul_f32 v15, 0x41000000, v67
    v_exp_f32 v12, v12
    v_exp_f32 v13, v13
    v_fract_f32 v14, v14
    v_fract_f32 v15, v15
    v_cos_f32 v80, v14
    v_sin_f32 v81, v14
    v_cos_f32 v82, v15
    v_sin_f32 v83, v15
    v_mul_f32 v80, v12, v80
    v_mul_f32 v81, v12, v81
    v_mul_f32 v82, v13, v82
    v_mul_f32 v83, v13, v83
    v_mul_f32 v12, 0x43800000, v64
    v_mul_f32 v13, 0x43800000, v65
    v_mul_f32 v14, 0x43800000, v66
    v_mul_f32 v15, 0x43800000, v67
    v_exp_f32 v12, v12
    v_exp_f32 v13, v13
    v_fract_f32 v14, v14
    v_fract_f32 v15, v15
    v_cos_f32 v84, v14
    v_sin_f32 v85, v14
    v_cos_f32 v86, v15
    v_sin_f32 v87, v15
    v_mul_f32 v84, v12, v84
    v_mul_f32 v85, v12, v85
    v_mul_f32 v86, v13, v86
    v_mul_f32 v87, v13, v87
    v_pk_mul_f32 v[128:129], v[72:73], v[68:69] op_sel:[0,0] op_sel_hi:[1,0]
    v_pk_mul_f32 v[130:131], v[74:75], v[70:71] op_sel:[0,0] op_sel_hi:[1,0]
    v_pk_fma_f32 v[128:129], v[72:73], v[68:69], v[128:129] op_sel:[1,1,0] op_sel_hi:[0,1,1] neg_lo:[1,0,0]
    v_pk_fma_f32 v[130:131], v[74:75], v[70:71], v[130:131] op_sel:[1,1,0] op_sel_hi:[0,1,1] neg_lo:[1,0,0]
    v_cvt_pk_bf16_f32 v8, v128, v129
    v_cvt_pk_bf16_f32 v9, v130, v131
    ds_write_b64 v2, v[8:9] offset:3696
    v_pk_mul_f32 v[88:89], v[128:129], v[76:77] op_sel:[0,0] op_sel_hi:[1,0]
    v_pk_mul_f32 v[90:91], v[130:131], v[78:79] op_sel:[0,0] op_sel_hi:[1,0]
    v_pk_fma_f32 v[88:89], v[128:129], v[76:77], v[88:89] op_sel:[1,1,0] op_sel_hi:[0,1,1] neg_lo:[1,0,0]
    v_pk_fma_f32 v[90:91], v[130:131], v[78:79], v[90:91] op_sel:[1,1,0] op_sel_hi:[0,1,1] neg_lo:[1,0,0]
    v_cvt_pk_bf16_f32 v10, v88, v89
    v_cvt_pk_bf16_f32 v11, v90, v91
    ds_write_b64 v2, v[10:11] offset:3168
    v_pk_mul_f32 v[132:133], v[88:89], v[76:77] op_sel:[0,0] op_sel_hi:[1,0]
    v_pk_mul_f32 v[134:135], v[90:91], v[78:79] op_sel:[0,0] op_sel_hi:[1,0]
    v_pk_fma_f32 v[132:133], v[88:89], v[76:77], v[132:133] op_sel:[1,1,0] op_sel_hi:[0,1,1] neg_lo:[1,0,0]
    v_pk_fma_f32 v[134:135], v[90:91], v[78:79], v[134:135] op_sel:[1,1,0] op_sel_hi:[0,1,1] neg_lo:[1,0,0]
    v_cvt_pk_bf16_f32 v8, v132, v133
    v_cvt_pk_bf16_f32 v9, v134, v135
    ds_write_b64 v2, v[8:9] offset:2640
    v_pk_mul_f32 v[92:93], v[132:133], v[76:77] op_sel:[0,0] op_sel_hi:[1,0]
    v_pk_mul_f32 v[94:95], v[134:135], v[78:79] op_sel:[0,0] op_sel_hi:[1,0]
    v_pk_fma_f32 v[92:93], v[132:133], v[76:77], v[92:93] op_sel:[1,1,0] op_sel_hi:[0,1,1] neg_lo:[1,0,0]
    v_pk_fma_f32 v[94:95], v[134:135], v[78:79], v[94:95] op_sel:[1,1,0] op_sel_hi:[0,1,1] neg_lo:[1,0,0]
    v_cvt_pk_bf16_f32 v10, v92, v93
    v_cvt_pk_bf16_f32 v11, v94, v95
    ds_write_b64 v2, v[10:11] offset:2112
    v_pk_mul_f32 v[136:137], v[92:93], v[76:77] op_sel:[0,0] op_sel_hi:[1,0]
    v_pk_mul_f32 v[138:139], v[94:95], v[78:79] op_sel:[0,0] op_sel_hi:[1,0]
    v_pk_fma_f32 v[136:137], v[92:93], v[76:77], v[136:137] op_sel:[1,1,0] op_sel_hi:[0,1,1] neg_lo:[1,0,0]
    v_pk_fma_f32 v[138:139], v[94:95], v[78:79], v[138:139] op_sel:[1,1,0] op_sel_hi:[0,1,1] neg_lo:[1,0,0]
    v_cvt_pk_bf16_f32 v8, v136, v137
    v_cvt_pk_bf16_f32 v9, v138, v139
    ds_write_b64 v2, v[8:9] offset:1584
    v_pk_mul_f32 v[88:89], v[136:137], v[76:77] op_sel:[0,0] op_sel_hi:[1,0]
    v_pk_mul_f32 v[90:91], v[138:139], v[78:79] op_sel:[0,0] op_sel_hi:[1,0]
    v_pk_fma_f32 v[88:89], v[136:137], v[76:77], v[88:89] op_sel:[1,1,0] op_sel_hi:[0,1,1] neg_lo:[1,0,0]
    v_pk_fma_f32 v[90:91], v[138:139], v[78:79], v[90:91] op_sel:[1,1,0] op_sel_hi:[0,1,1] neg_lo:[1,0,0]
    v_cvt_pk_bf16_f32 v10, v88, v89
    v_cvt_pk_bf16_f32 v11, v90, v91
    ds_write_b64 v2, v[10:11] offset:1056
    v_pk_mul_f32 v[140:141], v[88:89], v[76:77] op_sel:[0,0] op_sel_hi:[1,0]
    v_pk_mul_f32 v[142:143], v[90:91], v[78:79] op_sel:[0,0] op_sel_hi:[1,0]
    v_pk_fma_f32 v[140:141], v[88:89], v[76:77], v[140:141] op_sel:[1,1,0] op_sel_hi:[0,1,1] neg_lo:[1,0,0]
    v_pk_fma_f32 v[142:143], v[90:91], v[78:79], v[142:143] op_sel:[1,1,0] op_sel_hi:[0,1,1] neg_lo:[1,0,0]
    v_cvt_pk_bf16_f32 v8, v140, v141
    v_cvt_pk_bf16_f32 v9, v142, v143
    ds_write_b64 v2, v[8:9] offset:528
    v_pk_mul_f32 v[92:93], v[140:141], v[76:77] op_sel:[0,0] op_sel_hi:[1,0]
    v_pk_mul_f32 v[94:95], v[142:143], v[78:79] op_sel:[0,0] op_sel_hi:[1,0]
    v_pk_fma_f32 v[92:93], v[140:141], v[76:77], v[92:93] op_sel:[1,1,0] op_sel_hi:[0,1,1] neg_lo:[1,0,0]
    v_pk_fma_f32 v[94:95], v[142:143], v[78:79], v[94:95] op_sel:[1,1,0] op_sel_hi:[0,1,1] neg_lo:[1,0,0]
    v_cvt_pk_bf16_f32 v10, v92, v93
    v_cvt_pk_bf16_f32 v11, v94, v95
    ds_write_b64 v2, v[10:11] offset:0
    v_pk_mul_f32 v[144:145], v[128:129], v[80:81] op_sel:[0,0] op_sel_hi:[1,0]
    v_pk_mul_f32 v[146:147], v[130:131], v[82:83] op_sel:[0,0] op_sel_hi:[1,0]
    v_pk_fma_f32 v[144:145], v[128:129], v[80:81], v[144:145] op_sel:[1,1,0] op_sel_hi:[0,1,1] neg_lo:[1,0,0]
    v_pk_fma_f32 v[146:147], v[130:131], v[82:83], v[146:147] op_sel:[1,1,0] op_sel_hi:[0,1,1] neg_lo:[1,0,0]
    v_pk_mul_f32 v[96:97], v[128:129], v[84:85] op_sel:[0,0] op_sel_hi:[1,0]
    v_pk_mul_f32 v[98:99], v[130:131], v[86:87] op_sel:[0,0] op_sel_hi:[1,0]
    v_pk_fma_f32 v[96:97], v[128:129], v[84:85], v[96:97] op_sel:[1,1,0] op_sel_hi:[0,1,1] neg_lo:[1,0,0]
    v_pk_fma_f32 v[98:99], v[130:131], v[86:87], v[98:99] op_sel:[1,1,0] op_sel_hi:[0,1,1] neg_lo:[1,0,0]
    v_cvt_pk_bf16_f32 v8, v96, v97
    v_cvt_pk_bf16_f32 v9, v98, v99
    ds_write_b64 v2, v[8:9] offset:7920
    ds_write_b64 v2, v[8:9] offset:7392
    v_pk_mul_f32 v[100:101], v[136:137], v[84:85] op_sel:[0,0] op_sel_hi:[1,0]
    v_pk_mul_f32 v[102:103], v[138:139], v[86:87] op_sel:[0,0] op_sel_hi:[1,0]
    v_pk_fma_f32 v[100:101], v[136:137], v[84:85], v[100:101] op_sel:[1,1,0] op_sel_hi:[0,1,1] neg_lo:[1,0,0]
    v_pk_fma_f32 v[102:103], v[138:139], v[86:87], v[102:103] op_sel:[1,1,0] op_sel_hi:[0,1,1] neg_lo:[1,0,0]
    v_cvt_pk_bf16_f32 v10, v100, v101
    v_cvt_pk_bf16_f32 v11, v102, v103
    ds_write_b64 v2, v[10:11] offset:6336
    ds_write_b64 v2, v[10:11] offset:5808
    ds_write_b64 v2, v[10:11] offset:5280
    v_pk_mul_f32 v[88:89], v[132:133], v[84:85] op_sel:[0,0] op_sel_hi:[1,0]
    v_pk_mul_f32 v[90:91], v[134:135], v[86:87] op_sel:[0,0] op_sel_hi:[1,0]
    v_pk_fma_f32 v[88:89], v[132:133], v[84:85], v[88:89] op_sel:[1,1,0] op_sel_hi:[0,1,1] neg_lo:[1,0,0]
    v_pk_fma_f32 v[90:91], v[134:135], v[86:87], v[90:91] op_sel:[1,1,0] op_sel_hi:[0,1,1] neg_lo:[1,0,0]
    v_cvt_pk_bf16_f32 v8, v88, v89
    v_cvt_pk_bf16_f32 v9, v90, v91
    ds_write_b64 v2, v[8:9] offset:6864
    v_pk_mul_f32 v[92:93], v[140:141], v[84:85] op_sel:[0,0] op_sel_hi:[1,0]
    v_pk_mul_f32 v[94:95], v[142:143], v[86:87] op_sel:[0,0] op_sel_hi:[1,0]
    v_pk_fma_f32 v[92:93], v[140:141], v[84:85], v[92:93] op_sel:[1,1,0] op_sel_hi:[0,1,1] neg_lo:[1,0,0]
    v_pk_fma_f32 v[94:95], v[142:143], v[86:87], v[94:95] op_sel:[1,1,0] op_sel_hi:[0,1,1] neg_lo:[1,0,0]
    v_cvt_pk_bf16_f32 v10, v92, v93
    v_cvt_pk_bf16_f32 v11, v94, v95
    ds_write_b64 v2, v[10:11] offset:4752
    v_pk_mul_f32 v[88:89], v[144:145], v[84:85] op_sel:[0,0] op_sel_hi:[1,0]
    v_pk_mul_f32 v[90:91], v[146:147], v[86:87] op_sel:[0,0] op_sel_hi:[1,0]
    v_pk_fma_f32 v[88:89], v[144:145], v[84:85], v[88:89] op_sel:[1,1,0] op_sel_hi:[0,1,1] neg_lo:[1,0,0]
    v_pk_fma_f32 v[90:91], v[146:147], v[86:87], v[90:91] op_sel:[1,1,0] op_sel_hi:[0,1,1] neg_lo:[1,0,0]
    v_cvt_pk_bf16_f32 v8, v88, v89
    v_cvt_pk_bf16_f32 v9, v90, v91
    ds_write_b64 v2, v[8:9] offset:4224
    v_pk_mul_f32 v[104:105], v[96:97], v[84:85] op_sel:[0,0] op_sel_hi:[1,0]
    v_pk_mul_f32 v[106:107], v[98:99], v[86:87] op_sel:[0,0] op_sel_hi:[1,0]
    v_pk_fma_f32 v[104:105], v[96:97], v[84:85], v[104:105] op_sel:[1,1,0] op_sel_hi:[0,1,1] neg_lo:[1,0,0]
    v_pk_fma_f32 v[106:107], v[98:99], v[86:87], v[106:107] op_sel:[1,1,0] op_sel_hi:[0,1,1] neg_lo:[1,0,0]
    v_cvt_pk_bf16_f32 v10, v104, v105
    v_cvt_pk_bf16_f32 v11, v106, v107
    ds_write_b64 v2, v[10:11] offset:8448
    v_pk_mul_f32 v[108:109], v[100:101], v[84:85] op_sel:[0,0] op_sel_hi:[1,0]
    v_pk_mul_f32 v[110:111], v[102:103], v[86:87] op_sel:[0,0] op_sel_hi:[1,0]
    v_pk_fma_f32 v[108:109], v[100:101], v[84:85], v[108:109] op_sel:[1,1,0] op_sel_hi:[0,1,1] neg_lo:[1,0,0]
    v_pk_fma_f32 v[110:111], v[102:103], v[86:87], v[110:111] op_sel:[1,1,0] op_sel_hi:[0,1,1] neg_lo:[1,0,0]
    v_cvt_pk_bf16_f32 v8, v108, v109
    v_cvt_pk_bf16_f32 v9, v110, v111
    ds_write_b64 v2, v[8:9] offset:9504
    v_pk_mul_f32 v[88:89], v[104:105], v[84:85] op_sel:[0,0] op_sel_hi:[1,0]
    v_pk_mul_f32 v[90:91], v[106:107], v[86:87] op_sel:[0,0] op_sel_hi:[1,0]
    v_pk_fma_f32 v[88:89], v[104:105], v[84:85], v[88:89] op_sel:[1,1,0] op_sel_hi:[0,1,1] neg_lo:[1,0,0]
    v_pk_fma_f32 v[90:91], v[106:107], v[86:87], v[90:91] op_sel:[1,1,0] op_sel_hi:[0,1,1] neg_lo:[1,0,0]
    v_cvt_pk_bf16_f32 v10, v88, v89
    v_cvt_pk_bf16_f32 v11, v90, v91
    ds_write_b64 v2, v[10:11] offset:8976
    v_pk_mul_f32 v[92:93], v[108:109], v[84:85] op_sel:[0,0] op_sel_hi:[1,0]
    v_pk_mul_f32 v[94:95], v[110:111], v[86:87] op_sel:[0,0] op_sel_hi:[1,0]
    v_pk_fma_f32 v[92:93], v[108:109], v[84:85], v[92:93] op_sel:[1,1,0] op_sel_hi:[0,1,1] neg_lo:[1,0,0]
    v_pk_fma_f32 v[94:95], v[110:111], v[86:87], v[94:95] op_sel:[1,1,0] op_sel_hi:[0,1,1] neg_lo:[1,0,0]
    v_cvt_pk_bf16_f32 v8, v92, v93
    v_cvt_pk_bf16_f32 v9, v94, v95
    ds_write_b64 v2, v[8:9] offset:10032
    v_pk_mul_f32 v[96:97], v[88:89], v[84:85] op_sel:[0,0] op_sel_hi:[1,0]
    v_pk_mul_f32 v[98:99], v[90:91], v[86:87] op_sel:[0,0] op_sel_hi:[1,0]
    v_pk_fma_f32 v[96:97], v[88:89], v[84:85], v[96:97] op_sel:[1,1,0] op_sel_hi:[0,1,1] neg_lo:[1,0,0]
    v_pk_fma_f32 v[98:99], v[90:91], v[86:87], v[98:99] op_sel:[1,1,0] op_sel_hi:[0,1,1] neg_lo:[1,0,0]
    v_cvt_pk_bf16_f32 v10, v96, v97
    v_cvt_pk_bf16_f32 v11, v98, v99
    ds_write_b64 v2, v[10:11] offset:10560
    v_pk_mul_f32 v[100:101], v[96:97], v[84:85] op_sel:[0,0] op_sel_hi:[1,0]
    v_pk_mul_f32 v[102:103], v[98:99], v[86:87] op_sel:[0,0] op_sel_hi:[1,0]
    v_pk_fma_f32 v[100:101], v[96:97], v[84:85], v[100:101] op_sel:[1,1,0] op_sel_hi:[0,1,1] neg_lo:[1,0,0]
    v_pk_fma_f32 v[102:103], v[98:99], v[86:87], v[102:103] op_sel:[1,1,0] op_sel_hi:[0,1,1] neg_lo:[1,0,0]
    v_cvt_pk_bf16_f32 v8, v100, v101
    v_cvt_pk_bf16_f32 v9, v102, v103
    ds_write_b64 v2, v[8:9] offset:11088
    v_pk_mul_f32 v[96:97], v[100:101], v[84:85] op_sel:[0,0] op_sel_hi:[1,0]
    v_pk_mul_f32 v[98:99], v[102:103], v[86:87] op_sel:[0,0] op_sel_hi:[1,0]
    v_pk_fma_f32 v[96:97], v[100:101], v[84:85], v[96:97] op_sel:[1,1,0] op_sel_hi:[0,1,1] neg_lo:[1,0,0]
    v_pk_fma_f32 v[98:99], v[102:103], v[86:87], v[98:99] op_sel:[1,1,0] op_sel_hi:[0,1,1] neg_lo:[1,0,0]
    v_cvt_pk_bf16_f32 v10, v96, v97
    v_cvt_pk_bf16_f32 v11, v98, v99
    ds_write_b64 v2, v[10:11] offset:11616
    v_pk_mul_f32 v[100:101], v[96:97], v[84:85] op_sel:[0,0] op_sel_hi:[1,0]
    v_pk_mul_f32 v[102:103], v[98:99], v[86:87] op_sel:[0,0] op_sel_hi:[1,0]
    v_pk_fma_f32 v[100:101], v[96:97], v[84:85], v[100:101] op_sel:[1,1,0] op_sel_hi:[0,1,1] neg_lo:[1,0,0]
    v_pk_fma_f32 v[102:103], v[98:99], v[86:87], v[102:103] op_sel:[1,1,0] op_sel_hi:[0,1,1] neg_lo:[1,0,0]
    v_cvt_pk_bf16_f32 v8, v100, v101
    v_cvt_pk_bf16_f32 v9, v102, v103
    ds_write_b64 v2, v[8:9] offset:12144
    v_pk_mul_f32 v[96:97], v[100:101], v[84:85] op_sel:[0,0] op_sel_hi:[1,0]
    v_pk_mul_f32 v[98:99], v[102:103], v[86:87] op_sel:[0,0] op_sel_hi:[1,0]
    v_pk_fma_f32 v[96:97], v[100:101], v[84:85], v[96:97] op_sel:[1,1,0] op_sel_hi:[0,1,1] neg_lo:[1,0,0]
    v_pk_fma_f32 v[98:99], v[102:103], v[86:87], v[98:99] op_sel:[1,1,0] op_sel_hi:[0,1,1] neg_lo:[1,0,0]
    v_cvt_pk_bf16_f32 v10, v96, v97
    v_cvt_pk_bf16_f32 v11, v98, v99
    ds_write_b64 v2, v[10:11] offset:12672
    ds_read_b128 v[128:131], v3 offset:0
    ds_read_b128 v[132:135], v3 offset:32
    ds_read_b128 v[136:139], v3 offset:64
    ds_read_b128 v[140:143], v3 offset:96
    ds_read_b128 v[144:147], v3 offset:128
    ds_read_b128 v[148:151], v3 offset:160
    ds_read_b128 v[152:155], v3 offset:192
    ds_read_b128 v[156:159], v3 offset:224
    ds_read_b128 v[160:163], v3 offset:256
    ds_read_b128 v[164:167], v3 offset:288
    ds_read_b128 v[168:171], v3 offset:320
    ds_read_b128 v[172:175], v3 offset:352
    ds_read_b128 v[176:179], v3 offset:384
    ds_read_b128 v[180:183], v3 offset:416
    ds_read_b128 v[184:187], v3 offset:448
    ds_read_b128 v[188:191], v3 offset:480
    v_mov_b32 v8, 0x3f80
    v_mov_b32 v9, 0x3f80
    ds_write_b64 v2, v[8:9]
    v_cvt_pk_bf16_f32 v10, v80, -v81
    v_cvt_pk_bf16_f32 v11, v82, -v83
    ds_write_b64 v2, v[10:11] offset:528
    v_pk_mul_f32 v[88:89], v[80:81], v[80:81] op_sel:[0,0] op_sel_hi:[1,0]
    v_pk_mul_f32 v[90:91], v[82:83], v[82:83] op_sel:[0,0] op_sel_hi:[1,0]
    v_pk_fma_f32 v[88:89], v[80:81], v[80:81], v[88:89] op_sel:[1,1,0] op_sel_hi:[0,1,1] neg_lo:[1,0,0]
    v_pk_fma_f32 v[90:91], v[82:83], v[82:83], v[90:91] op_sel:[1,1,0] op_sel_hi:[0,1,1] neg_lo:[1,0,0]
    v_cvt_pk_bf16_f32 v8, v88, -v89
    v_cvt_pk_bf16_f32 v9, v90, -v91
    ds_write_b64 v2, v[8:9] offset:1056
    v_pk_mul_f32 v[92:93], v[88:89], v[80:81] op_sel:[0,0] op_sel_hi:[1,0]
    v_pk_mul_f32 v[94:95], v[90:91], v[82:83] op_sel:[0,0] op_sel_hi:[1,0]
    v_pk_fma_f32 v[92:93], v[88:89], v[80:81], v[92:93] op_sel:[1,1,0] op_sel_hi:[0,1,1] neg_lo:[1,0,0]
    v_pk_fma_f32 v[94:95], v[90:91], v[82:83], v[94:95] op_sel:[1,1,0] op_sel_hi:[0,1,1] neg_lo:[1,0,0]
    v_cvt_pk_bf16_f32 v10, v92, -v93
    v_cvt_pk_bf16_f32 v11, v94, -v95
    ds_write_b64 v2, v[10:11] offset:1584
    v_pk_mul_f32 v[88:89], v[92:93], v[80:81] op_sel:[0,0] op_sel_hi:[1,0]
    v_pk_mul_f32 v[90:91], v[94:95], v[82:83] op_sel:[0,0] op_sel_hi:[1,0]
    v_pk_fma_f32 v[88:89], v[92:93], v[80:81], v[88:89] op_sel:[1,1,0] op_sel_hi:[0,1,1] neg_lo:[1,0,0]
    v_pk_fma_f32 v[90:91], v[94:95], v[82:83], v[90:91] op_sel:[1,1,0] op_sel_hi:[0,1,1] neg_lo:[1,0,0]
    v_cvt_pk_bf16_f32 v8, v88, -v89
    v_cvt_pk_bf16_f32 v9, v90, -v91
    ds_write_b64 v2, v[8:9] offset:2112
    v_pk_mul_f32 v[92:93], v[88:89], v[80:81] op_sel:[0,0] op_sel_hi:[1,0]
    v_pk_mul_f32 v[94:95], v[90:91], v[82:83] op_sel:[0,0] op_sel_hi:[1,0]
    v_pk_fma_f32 v[92:93], v[88:89], v[80:81], v[92:93] op_sel:[1,1,0] op_sel_hi:[0,1,1] neg_lo:[1,0,0]
    v_pk_fma_f32 v[94:95], v[90:91], v[82:83], v[94:95] op_sel:[1,1,0] op_sel_hi:[0,1,1] neg_lo:[1,0,0]
    v_cvt_pk_bf16_f32 v10, v92, -v93
    v_cvt_pk_bf16_f32 v11, v94, -v95
    ds_write_b64 v2, v[10:11] offset:2640
    v_pk_mul_f32 v[88:89], v[92:93], v[80:81] op_sel:[0,0] op_sel_hi:[1,0]
    v_pk_mul_f32 v[90:91], v[94:95], v[82:83] op_sel:[0,0] op_sel_hi:[1,0]
    v_pk_fma_f32 v[88:89], v[92:93], v[80:81], v[88:89] op_sel:[1,1,0] op_sel_hi:[0,1,1] neg_lo:[1,0,0]
    v_pk_fma_f32 v[90:91], v[94:95], v[82:83], v[90:91] op_sel:[1,1,0] op_sel_hi:[0,1,1] neg_lo:[1,0,0]
    v_cvt_pk_bf16_f32 v8, v88, -v89
    v_cvt_pk_bf16_f32 v9, v90, -v91
    ds_write_b64 v2, v[8:9] offset:3168
    v_pk_mul_f32 v[92:93], v[88:89], v[80:81] op_sel:[0,0] op_sel_hi:[1,0]
    v_pk_mul_f32 v[94:95], v[90:91], v[82:83] op_sel:[0,0] op_sel_hi:[1,0]
    v_pk_fma_f32 v[92:93], v[88:89], v[80:81], v[92:93] op_sel:[1,1,0] op_sel_hi:[0,1,1] neg_lo:[1,0,0]
    v_pk_fma_f32 v[94:95], v[90:91], v[82:83], v[94:95] op_sel:[1,1,0] op_sel_hi:[0,1,1] neg_lo:[1,0,0]
    v_cvt_pk_bf16_f32 v10, v92, -v93
    v_cvt_pk_bf16_f32 v11, v94, -v95
    ds_write_b64 v2, v[10:11] offset:3696
    v_pk_mul_f32 v[88:89], v[92:93], v[80:81] op_sel:[0,0] op_sel_hi:[1,0]
    v_pk_mul_f32 v[90:91], v[94:95], v[82:83] op_sel:[0,0] op_sel_hi:[1,0]
    v_pk_fma_f32 v[88:89], v[92:93], v[80:81], v[88:89] op_sel:[1,1,0] op_sel_hi:[0,1,1] neg_lo:[1,0,0]
    v_pk_fma_f32 v[90:91], v[94:95], v[82:83], v[90:91] op_sel:[1,1,0] op_sel_hi:[0,1,1] neg_lo:[1,0,0]
    v_cvt_pk_bf16_f32 v8, v88, -v89
    v_cvt_pk_bf16_f32 v9, v90, -v91
    ds_write_b64 v2, v[8:9] offset:4224
    v_pk_mul_f32 v[92:93], v[88:89], v[80:81] op_sel:[0,0] op_sel_hi:[1,0]
    v_pk_mul_f32 v[94:95], v[90:91], v[82:83] op_sel:[0,0] op_sel_hi:[1,0]
    v_pk_fma_f32 v[92:93], v[88:89], v[80:81], v[92:93] op_sel:[1,1,0] op_sel_hi:[0,1,1] neg_lo:[1,0,0]
    v_pk_fma_f32 v[94:95], v[90:91], v[82:83], v[94:95] op_sel:[1,1,0] op_sel_hi:[0,1,1] neg_lo:[1,0,0]
    v_cvt_pk_bf16_f32 v10, v92, -v93
    v_cvt_pk_bf16_f32 v11, v94, -v95
    ds_write_b64 v2, v[10:11] offset:4752
    v_pk_mul_f32 v[88:89], v[92:93], v[80:81] op_sel:[0,0] op_sel_hi:[1,0]
    v_pk_mul_f32 v[90:91], v[94:95], v[82:83] op_sel:[0,0] op_sel_hi:[1,0]
    v_pk_fma_f32 v[88:89], v[92:93], v[80:81], v[88:89] op_sel:[1,1,0] op_sel_hi:[0,1,1] neg_lo:[1,0,0]
    v_pk_fma_f32 v[90:91], v[94:95], v[82:83], v[90:91] op_sel:[1,1,0] op_sel_hi:[0,1,1] neg_lo:[1,0,0]
    v_cvt_pk_bf16_f32 v8, v88, -v89
    v_cvt_pk_bf16_f32 v9, v90, -v91
    ds_write_b64 v2, v[8:9] offset:5280
    v_pk_mul_f32 v[92:93], v[88:89], v[80:81] op_sel:[0,0] op_sel_hi:[1,0]
    v_pk_mul_f32 v[94:95], v[90:91], v[82:83] op_sel:[0,0] op_sel_hi:[1,0]
    v_pk_fma_f32 v[92:93], v[88:89], v[80:81], v[92:93] op_sel:[1,1,0] op_sel_hi:[0,1,1] neg_lo:[1,0,0]
    v_pk_fma_f32 v[94:95], v[90:91], v[82:83], v[94:95] op_sel:[1,1,0] op_sel_hi:[0,1,1] neg_lo:[1,0,0]
    v_cvt_pk_bf16_f32 v10, v92, -v93
    v_cvt_pk_bf16_f32 v11, v94, -v95
    ds_write_b64 v2, v[10:11] offset:5808
    v_pk_mul_f32 v[88:89], v[92:93], v[80:81] op_sel:[0,0] op_sel_hi:[1,0]
    v_pk_mul_f32 v[90:91], v[94:95], v[82:83] op_sel:[0,0] op_sel_hi:[1,0]
    v_pk_fma_f32 v[88:89], v[92:93], v[80:81], v[88:89] op_sel:[1,1,0] op_sel_hi:[0,1,1] neg_lo:[1,0,0]
    v_pk_fma_f32 v[90:91], v[94:95], v[82:83], v[90:91] op_sel:[1,1,0] op_sel_hi:[0,1,1] neg_lo:[1,0,0]
    v_cvt_pk_bf16_f32 v8, v88, -v89
    v_cvt_pk_bf16_f32 v9, v90, -v91
    ds_write_b64 v2, v[8:9] offset:6336
    v_pk_mul_f32 v[92:93], v[88:89], v[80:81] op_sel:[0,0] op_sel_hi:[1,0]
    v_pk_mul_f32 v[94:95], v[90:91], v[82:83] op_sel:[0,0] op_sel_hi:[1,0]
    v_pk_fma_f32 v[92:93], v[88:89], v[80:81], v[92:93] op_sel:[1,1,0] op_sel_hi:[0,1,1] neg_lo:[1,0,0]
    v_pk_fma_f32 v[94:95], v[90:91], v[82:83], v[94:95] op_sel:[1,1,0] op_sel_hi:[0,1,1] neg_lo:[1,0,0]
    v_cvt_pk_bf16_f32 v10, v92, -v93
    v_cvt_pk_bf16_f32 v11, v94, -v95
    ds_write_b64 v2, v[10:11] offset:6864
    v_pk_mul_f32 v[88:89], v[92:93], v[80:81] op_sel:[0,0] op_sel_hi:[1,0]
    v_pk_mul_f32 v[90:91], v[94:95], v[82:83] op_sel:[0,0] op_sel_hi:[1,0]
    v_pk_fma_f32 v[88:89], v[92:93], v[80:81], v[88:89] op_sel:[1,1,0] op_sel_hi:[0,1,1] neg_lo:[1,0,0]
    v_pk_fma_f32 v[90:91], v[94:95], v[82:83], v[90:91] op_sel:[1,1,0] op_sel_hi:[0,1,1] neg_lo:[1,0,0]
    v_cvt_pk_bf16_f32 v8, v88, -v89
    v_cvt_pk_bf16_f32 v9, v90, -v91
    ds_write_b64 v2, v[8:9] offset:7392
    v_pk_mul_f32 v[92:93], v[88:89], v[80:81] op_sel:[0,0] op_sel_hi:[1,0]
    v_pk_mul_f32 v[94:95], v[90:91], v[82:83] op_sel:[0,0] op_sel_hi:[1,0]
    v_pk_fma_f32 v[92:93], v[88:89], v[80:81], v[92:93] op_sel:[1,1,0] op_sel_hi:[0,1,1] neg_lo:[1,0,0]
    v_pk_fma_f32 v[94:95], v[90:91], v[82:83], v[94:95] op_sel:[1,1,0] op_sel_hi:[0,1,1] neg_lo:[1,0,0]
    v_cvt_pk_bf16_f32 v10, v92, -v93
    v_cvt_pk_bf16_f32 v11, v94, -v95
    ds_write_b64 v2, v[10:11] offset:7920
    v_pk_mul_f32 v[88:89], v[92:93], v[80:81] op_sel:[0,0] op_sel_hi:[1,0]
    v_pk_mul_f32 v[90:91], v[94:95], v[82:83] op_sel:[0,0] op_sel_hi:[1,0]
    v_pk_fma_f32 v[88:89], v[92:93], v[80:81], v[88:89] op_sel:[1,1,0] op_sel_hi:[0,1,1] neg_lo:[1,0,0]
    v_pk_fma_f32 v[90:91], v[94:95], v[82:83], v[90:91] op_sel:[1,1,0] op_sel_hi:[0,1,1] neg_lo:[1,0,0]
    v_cvt_pk_bf16_f32 v8, v88, -v89
    v_cvt_pk_bf16_f32 v9, v90, -v91
    ds_write_b64 v2, v[8:9] offset:8448
    v_pk_mul_f32 v[92:93], v[88:89], v[80:81] op_sel:[0,0] op_sel_hi:[1,0]
    v_pk_mul_f32 v[94:95], v[90:91], v[82:83] op_sel:[0,0] op_sel_hi:[1,0]
    v_pk_fma_f32 v[92:93], v[88:89], v[80:81], v[92:93] op_sel:[1,1,0] op_sel_hi:[0,1,1] neg_lo:[1,0,0]
    v_pk_fma_f32 v[94:95], v[90:91], v[82:83], v[94:95] op_sel:[1,1,0] op_sel_hi:[0,1,1] neg_lo:[1,0,0]
    v_cvt_pk_bf16_f32 v10, v92, -v93
    v_cvt_pk_bf16_f32 v11, v94, -v95
    ds_write_b64 v2, v[10:11] offset:8976
    v_pk_mul_f32 v[88:89], v[92:93], v[80:81] op_sel:[0,0] op_sel_hi:[1,0]
    v_pk_mul_f32 v[90:91], v[94:95], v[82:83] op_sel:[0,0] op_sel_hi:[1,0]
    v_pk_fma_f32 v[88:89], v[92:93], v[80:81], v[88:89] op_sel:[1,1,0] op_sel_hi:[0,1,1] neg_lo:[1,0,0]
    v_pk_fma_f32 v[90:91], v[94:95], v[82:83], v[90:91] op_sel:[1,1,0] op_sel_hi:[0,1,1] neg_lo:[1,0,0]
    v_cvt_pk_bf16_f32 v8, v88, -v89
    v_cvt_pk_bf16_f32 v9, v90, -v91
    ds_write_b64 v2, v[8:9] offset:9504
    v_pk_mul_f32 v[92:93], v[88:89], v[80:81] op_sel:[0,0] op_sel_hi:[1,0]
    v_pk_mul_f32 v[94:95], v[90:91], v[82:83] op_sel:[0,0] op_sel_hi:[1,0]
    v_pk_fma_f32 v[92:93], v[88:89], v[80:81], v[92:93] op_sel:[1,1,0] op_sel_hi:[0,1,1] neg_lo:[1,0,0]
    v_pk_fma_f32 v[94:95], v[90:91], v[82:83], v[94:95] op_sel:[1,1,0] op_sel_hi:[0,1,1] neg_lo:[1,0,0]
    v_cvt_pk_bf16_f32 v10, v92, -v93
    v_cvt_pk_bf16_f32 v11, v94, -v95
    ds_write_b64 v2, v[10:11] offset:10032
    v_pk_mul_f32 v[88:89], v[92:93], v[80:81] op_sel:[0,0] op_sel_hi:[1,0]
    v_pk_mul_f32 v[90:91], v[94:95], v[82:83] op_sel:[0,0] op_sel_hi:[1,0]
    v_pk_fma_f32 v[88:89], v[92:93], v[80:81], v[88:89] op_sel:[1,1,0] op_sel_hi:[0,1,1] neg_lo:[1,0,0]
    v_pk_fma_f32 v[90:91], v[94:95], v[82:83], v[90:91] op_sel:[1,1,0] op_sel_hi:[0,1,1] neg_lo:[1,0,0]
    v_cvt_pk_bf16_f32 v8, v88, -v89
    v_cvt_pk_bf16_f32 v9, v90, -v91
    ds_write_b64 v2, v[8:9] offset:10560
    v_pk_mul_f32 v[92:93], v[88:89], v[80:81] op_sel:[0,0] op_sel_hi:[1,0]
    v_pk_mul_f32 v[94:95], v[90:91], v[82:83] op_sel:[0,0] op_sel_hi:[1,0]
    v_pk_fma_f32 v[92:93], v[88:89], v[80:81], v[92:93] op_sel:[1,1,0] op_sel_hi:[0,1,1] neg_lo:[1,0,0]
    v_pk_fma_f32 v[94:95], v[90:91], v[82:83], v[94:95] op_sel:[1,1,0] op_sel_hi:[0,1,1] neg_lo:[1,0,0]
    v_cvt_pk_bf16_f32 v10, v92, -v93
    v_cvt_pk_bf16_f32 v11, v94, -v95
    ds_write_b64 v2, v[10:11] offset:11088
    v_pk_mul_f32 v[88:89], v[92:93], v[80:81] op_sel:[0,0] op_sel_hi:[1,0]
    v_pk_mul_f32 v[90:91], v[94:95], v[82:83] op_sel:[0,0] op_sel_hi:[1,0]
    v_pk_fma_f32 v[88:89], v[92:93], v[80:81], v[88:89] op_sel:[1,1,0] op_sel_hi:[0,1,1] neg_lo:[1,0,0]
    v_pk_fma_f32 v[90:91], v[94:95], v[82:83], v[90:91] op_sel:[1,1,0] op_sel_hi:[0,1,1] neg_lo:[1,0,0]
    v_cvt_pk_bf16_f32 v8, v88, -v89
    v_cvt_pk_bf16_f32 v9, v90, -v91
    ds_write_b64 v2, v[8:9] offset:11616
    v_pk_mul_f32 v[92:93], v[88:89], v[80:81] op_sel:[0,0] op_sel_hi:[1,0]
    v_pk_mul_f32 v[94:95], v[90:91], v[82:83] op_sel:[0,0] op_sel_hi:[1,0]
    v_pk_fma_f32 v[92:93], v[88:89], v[80:81], v[92:93] op_sel:[1,1,0] op_sel_hi:[0,1,1] neg_lo:[1,0,0]
    v_pk_fma_f32 v[94:95], v[90:91], v[82:83], v[94:95] op_sel:[1,1,0] op_sel_hi:[0,1,1] neg_lo:[1,0,0]
    v_cvt_pk_bf16_f32 v10, v92, -v93
    v_cvt_pk_bf16_f32 v11, v94, -v95
    ds_write_b64 v2, v[10:11] offset:12144
    v_pk_mul_f32 v[88:89], v[92:93], v[80:81] op_sel:[0,0] op_sel_hi:[1,0]
    v_pk_mul_f32 v[90:91], v[94:95], v[82:83] op_sel:[0,0] op_sel_hi:[1,0]
    v_pk_fma_f32 v[88:89], v[92:93], v[80:81], v[88:89] op_sel:[1,1,0] op_sel_hi:[0,1,1] neg_lo:[1,0,0]
    v_pk_fma_f32 v[90:91], v[94:95], v[82:83], v[90:91] op_sel:[1,1,0] op_sel_hi:[0,1,1] neg_lo:[1,0,0]
    v_cvt_pk_bf16_f32 v8, v88, -v89
    v_cvt_pk_bf16_f32 v9, v90, -v91
    ds_write_b64 v2, v[8:9] offset:12672
    v_pk_mul_f32 v[92:93], v[88:89], v[80:81] op_sel:[0,0] op_sel_hi:[1,0]
    v_pk_mul_f32 v[94:95], v[90:91], v[82:83] op_sel:[0,0] op_sel_hi:[1,0]
    v_pk_fma_f32 v[92:93], v[88:89], v[80:81], v[92:93] op_sel:[1,1,0] op_sel_hi:[0,1,1] neg_lo:[1,0,0]
    v_pk_fma_f32 v[94:95], v[90:91], v[82:83], v[94:95] op_sel:[1,1,0] op_sel_hi:[0,1,1] neg_lo:[1,0,0]
    v_cvt_pk_bf16_f32 v10, v92, -v93
    v_cvt_pk_bf16_f32 v11, v94, -v95
    ds_write_b64 v2, v[10:11] offset:13200
    v_pk_mul_f32 v[88:89], v[92:93], v[80:81] op_sel:[0,0] op_sel_hi:[1,0]
    v_pk_mul_f32 v[90:91], v[94:95], v[82:83] op_sel:[0,0] op_sel_hi:[1,0]
    v_pk_fma_f32 v[88:89], v[92:93], v[80:81], v[88:89] op_sel:[1,1,0] op_sel_hi:[0,1,1] neg_lo:[1,0,0]
    v_pk_fma_f32 v[90:91], v[94:95], v[82:83], v[90:91] op_sel:[1,1,0] op_sel_hi:[0,1,1] neg_lo:[1,0,0]
    v_cvt_pk_bf16_f32 v8, v88, -v89
    v_cvt_pk_bf16_f32 v9, v90, -v91
    ds_write_b64 v2, v[8:9] offset:13728
    v_pk_mul_f32 v[92:93], v[88:89], v[80:81] op_sel:[0,0] op_sel_hi:[1,0]
    v_pk_mul_f32 v[94:95], v[90:91], v[82:83] op_sel:[0,0] op_sel_hi:[1,0]
    v_pk_fma_f32 v[92:93], v[88:89], v[80:81], v[92:93] op_sel:[1,1,0] op_sel_hi:[0,1,1] neg_lo:[1,0,0]
    v_pk_fma_f32 v[94:95], v[90:91], v[82:83], v[94:95] op_sel:[1,1,0] op_sel_hi:[0,1,1] neg_lo:[1,0,0]
    v_cvt_pk_bf16_f32 v10, v92, -v93
    v_cvt_pk_bf16_f32 v11, v94, -v95
    ds_write_b64 v2, v[10:11] offset:14256
    v_pk_mul_f32 v[88:89], v[92:93], v[80:81] op_sel:[0,0] op_sel_hi:[1,0]
    v_pk_mul_f32 v[90:91], v[94:95], v[82:83] op_sel:[0,0] op_sel_hi:[1,0]
    v_pk_fma_f32 v[88:89], v[92:93], v[80:81], v[88:89] op_sel:[1,1,0] op_sel_hi:[0,1,1] neg_lo:[1,0,0]
    v_pk_fma_f32 v[90:91], v[94:95], v[82:83], v[90:91] op_sel:[1,1,0] op_sel_hi:[0,1,1] neg_lo:[1,0,0]
    v_cvt_pk_bf16_f32 v8, v88, -v89
    v_cvt_pk_bf16_f32 v9, v90, -v91
    ds_write_b64 v2, v[8:9] offset:14784
    v_pk_mul_f32 v[92:93], v[88:89], v[80:81] op_sel:[0,0] op_sel_hi:[1,0]
    v_pk_mul_f32 v[94:95], v[90:91], v[82:83] op_sel:[0,0] op_sel_hi:[1,0]
    v_pk_fma_f32 v[92:93], v[88:89], v[80:81], v[92:93] op_sel:[1,1,0] op_sel_hi:[0,1,1] neg_lo:[1,0,0]
    v_pk_fma_f32 v[94:95], v[90:91], v[82:83], v[94:95] op_sel:[1,1,0] op_sel_hi:[0,1,1] neg_lo:[1,0,0]
    v_cvt_pk_bf16_f32 v10, v92, -v93
    v_cvt_pk_bf16_f32 v11, v94, -v95
    ds_write_b64 v2, v[10:11] offset:15312
    v_pk_mul_f32 v[88:89], v[92:93], v[80:81] op_sel:[0,0] op_sel_hi:[1,0]
    v_pk_mul_f32 v[90:91], v[94:95], v[82:83] op_sel:[0,0] op_sel_hi:[1,0]
    v_pk_fma_f32 v[88:89], v[92:93], v[80:81], v[88:89] op_sel:[1,1,0] op_sel_hi:[0,1,1] neg_lo:[1,0,0]
    v_pk_fma_f32 v[90:91], v[94:95], v[82:83], v[90:91] op_sel:[1,1,0] op_sel_hi:[0,1,1] neg_lo:[1,0,0]
    v_cvt_pk_bf16_f32 v8, v88, -v89
    v_cvt_pk_bf16_f32 v9, v90, -v91
    ds_write_b64 v2, v[8:9] offset:15840
    v_pk_mul_f32 v[92:93], v[88:89], v[80:81] op_sel:[0,0] op_sel_hi:[1,0]
    v_pk_mul_f32 v[94:95], v[90:91], v[82:83] op_sel:[0,0] op_sel_hi:[1,0]
    v_pk_fma_f32 v[92:93], v[88:89], v[80:81], v[92:93] op_sel:[1,1,0] op_sel_hi:[0,1,1] neg_lo:[1,0,0]
    v_pk_fma_f32 v[94:95], v[90:91], v[82:83], v[94:95] op_sel:[1,1,0] op_sel_hi:[0,1,1] neg_lo:[1,0,0]
    v_cvt_pk_bf16_f32 v10, v92, -v93
    v_cvt_pk_bf16_f32 v11, v94, -v95
    ds_write_b64 v2, v[10:11] offset:16368
    ds_read_b128 v[192:195], v3 offset:0
    ds_read_b128 v[196:199], v3 offset:32
    ds_read_b128 v[200:203], v3 offset:64
    ds_read_b128 v[204:207], v3 offset:96
    ds_read_b128 v[208:211], v3 offset:128
    ds_read_b128 v[212:215], v3 offset:160
    ds_read_b128 v[216:219], v3 offset:192
    ds_read_b128 v[220:223], v3 offset:224
    ds_read_b128 v[224:227], v3 offset:256
    ds_read_b128 v[228:231], v3 offset:288
    ds_read_b128 v[232:235], v3 offset:320
    ds_read_b128 v[236:239], v3 offset:352
    ds_read_b128 v[240:243], v3 offset:384
    ds_read_b128 v[244:247], v3 offset:416
    ds_read_b128 v[248:251], v3 offset:448
    ds_read_b128 v[252:255], v3 offset:480
    v_mov_b32 v107, v7
    v_mov_b32 v108, v4
    v_lshrrev_b32 v4, 2, v0
    v_mul_u32_u24 v109, 1024, v4
    v_and_b32 v6, 3, v0
    v_lshl_add_u32 v109, v6, 4, v109
    v_add_u32 v110, s59, v7
    s_waitcnt vmcnt(0)
    s_waitcnt lgkmcnt(0)
    s_add_u32 s62, s62, 1
    s_cmp_eq_u32 s62, -1
    s_cselect_b32 s62, 0, s62
    v_mfma_f32_32x32x16_bf16 v[112:127], v[128:131], v[192:195], 0
    v_mul_u32_u24 v96, 20480, v6
    v_lshrrev_b32 v5, 3, v4
    v_mul_u32_u24 v5, 144, v5
    v_and_b32 v4, 7, v4
    v_lshl_add_u32 v5, v4, 4, v5
    v_mfma_f32_32x32x16_bf16 v[112:127], v[132:135], v[196:199], v[112:127]
    v_add_u32 v96, v96, v5
    v_mov_b32 v88, 0
    v_mov_b32 v89, 0
    v_mov_b32 v90, 0
    v_mov_b32 v91, 0
    v_mfma_f32_32x32x16_bf16 v[112:127], v[136:139], v[200:203], v[112:127]
    v_lshl_add_u32 v92, v1, 4, s59
    ds_write_b128 v92, v[88:91] offset:0
    ds_write_b128 v92, v[88:91] offset:272
    ds_write_b128 v92, v[88:91] offset:5904
    ds_write_b128 v92, v[88:91] offset:6928
    v_mfma_f32_32x32x16_bf16 v[112:127], v[140:143], v[204:207], v[112:127]
    ds_write_b128 v92, v[88:91] offset:7952
    ds_write_b128 v92, v[88:91] offset:8976
    ds_write_b128 v92, v[88:91] offset:9216
    ds_write_b128 v92, v[88:91] offset:10240
    ds_write_b128 v92, v[88:91] offset:11264
    v_mfma_f32_32x32x16_bf16 v[112:127], v[144:147], v[208:211], v[112:127]
    ds_write_b128 v92, v[88:91] offset:11392
    v_and_b32 v4, 31, v1
    v_lshrrev_b32 v5, 5, v1
    v_lshlrev_b32 v97, 3, v5
    v_lshlrev_b32 v93, 4, v4
    v_mfma_f32_32x32x16_bf16 v[112:127], v[148:151], v[212:215], v[112:127]
    v_sub_u32 v97, v97, v93
    v_add_u32 v97, s59, v97
    v_add_u32 v97, 6510, v97
    v_cmp_eq_u32 vcc, 32, v1
    v_and_b32 v93, 1, v1
    v_mfma_f32_32x32x16_bf16 v[112:127], v[152:155], v[216:219], v[112:127]
    v_cndmask_b32 v63, 0, v63, vcc
    v_cmp_eq_u32 vcc, 1, v93
    v_cmp_gt_u32 s[60:61], 32, v1
    v_and_b32 v93, 30, v1
    v_subrev_u32 v93, s59, v93
    v_mfma_f32_32x32x16_bf16 v[112:127], v[156:159], v[220:223], v[112:127]
    v_mov_b32 v94, 8770
    v_mov_b32 v95, 8512
    v_cndmask_b32 v94, v94, v95, vcc
    v_mov_b32 v95, 9090
    v_mov_b32 v100, 8928
    v_mfma_f32_32x32x16_bf16 v[112:127], v[160:163], v[224:227], v[112:127]
    v_cndmask_b32 v95, v95, v100, vcc
    v_cndmask_b32 v94, v95, v94, s[60:61]
    v_sub_u32 v98, v94, v93
    v_mov_b32 v94, 8384
    v_mov_b32 v95, 8640
    v_mfma_f32_32x32x16_bf16 v[112:127], v[164:167], v[228:231], v[112:127]
    v_cndmask_b32 v94, v94, v95, vcc
    v_mov_b32 v95, 9026
    v_mov_b32 v100, 8864
    v_cndmask_b32 v95, v95, v100, vcc
    v_cndmask_b32 v94, v95, v94, s[60:61]
    v_mfma_f32_32x32x16_bf16 v[112:127], v[168:171], v[232:235], v[112:127]
    v_sub_u32 v99, v94, v93
    v_and_b32 v12, 15, v1
    v_lshrrev_b32 v13, 4, v1
    v_lshlrev_b32 v14, 3, v13
    v_lshlrev_b32 v15, 1, v12
    v_mfma_f32_32x32x16_bf16 v[112:127], v[172:175], v[236:239], v[112:127]
    v_sub_u32 v2, v14, v15
    v_and_b32 v15, 1, v1
    v_mul_u32_u24 v15, 958, v15
    v_add3_u32 v2, v2, v15, s59
    v_add_u32 v2, 8320, v2
    v_mfma_f32_32x32x16_bf16 v[112:127], v[176:179], v[240:243], v[112:127]
    v_lshl_add_u32 v14, v12, 4, v14
    v_add_u32 v15, 48, v14
    v_lshrrev_b32 v3, 6, v15
    v_lshlrev_b32 v3, 4, v3
    v_lshl_add_u32 v3, v15, 1, v3
    v_mfma_f32_32x32x16_bf16 v[112:127], v[180:183], v[244:247], v[112:127]
    v_add_u32 v3, s59, v3
    v_add_u32 v15, 40, v14
    v_lshrrev_b32 v6, 6, v15
    v_lshlrev_b32 v6, 4, v6
    v_lshl_add_u32 v6, v15, 1, v6
    v_mfma_f32_32x32x16_bf16 v[112:127], v[184:187], v[248:251], v[112:127]
    v_add_u32 v6, s59, v6
    v_lshlrev_b32 v7, 6, v12
    v_lshl_add_u32 v7, v13, 4, v7
    v_lshrrev_b32 v15, 2, v12
    v_lshl_add_u32 v7, v15, 4, v7
    v_mfma_f32_32x32x16_bf16 v[112:127], v[188:191], v[252:255], v[112:127]
    v_add_u32 v7, s59, v7
    v_lshlrev_b32 v14, 4, v5
    v_lshlrev_b32 v15, 1, v4
    v_sub_u32 v8, v14, v15
    v_and_b32 v15, 1, v1
    v_mul_u32_u24 v15, 1218, v15
    v_add3_u32 v8, v8, v15, s59
    v_add_u32 v8, 5980, v8
    v_add_u32 v9, 576, v8
    v_mul_u32_u24 v10, 144, v4
    v_add3_u32 v10, v10, v14, s59
    v_mul_u32_u24 v11, 272, v4
    v_add3_u32 v11, v11, v14, s59
    v_mov_b32 v101, s59
    v_add_f32 v115, v115, v63
    v_cvt_pk_bf16_f32 v88, v112, v113
    v_cvt_pk_bf16_f32 v89, v114, v115
    v_cvt_pk_bf16_f32 v90, v113, v114
    ds_write_b64 v97, v[88:89] offset:1730
    ds_write_b16 v97, v88 offset:512
    ds_write_b32 v97, v90 offset:514
    ds_write_b16_d16_hi v97, v89 offset:518
    v_cvt_pk_bf16_f32 v92, v116, v117
    v_cvt_pk_bf16_f32 v93, v118, v119
    v_cvt_pk_bf16_f32 v94, v117, v118
    ds_write_b64 v97, v[92:93] offset:1218
    ds_write_b16 v97, v92 offset:0
    ds_write_b32 v97, v94 offset:2
    ds_write_b16_d16_hi v97, v93 offset:6
    v_cvt_pk_bf16_f32 v102, v120, v121
    v_cvt_pk_bf16_f32 v103, v122, v123
    v_cvt_pk_bf16_f32 v104, v124, v120
    ds_write_b16_d16_hi v98, v102
    ds_write_b16_d16_hi v98, v102 offset:958
    ds_write_b16 v99, v103 offset:32
    ds_write_b16 v99, v103 offset:990
    ds_write_b16_d16_hi v99, v103
    ds_write_b16_d16_hi v99, v103 offset:958
    s_mov_b32 exec_lo, -2
    s_mov_b32 exec_hi, -2
    ds_write_b16 v98, v102 offset:32
    ds_write_b16 v98, v102 offset:990
    s_mov_b64 exec, 1
    ds_write_b16 v101, v102 offset:6012
    ds_write_b16 v101, v102 offset:7230
    ds_write_b16 v101, v102 offset:6010
    ds_write_b16 v101, v102 offset:7228
    ds_write_b16 v101, v102 offset:6008
    ds_write_b16 v101, v102 offset:7226
    ds_write_b16 v101, v104 offset:8994
    ds_write_b16 v101, v104 offset:9952
    s_mov_b32 exec_hi, 1
    s_mov_b32 exec_lo, 0
    ds_write_b16 v101, v102 offset:8738
    ds_write_b16 v101, v102 offset:9696
    ds_write_b16 v101, v102 offset:9184
    ds_write_b16 v101, v102 offset:10142
    s_mov_b64 exec, -1
    v_lshrrev_b32 v58, 4, v1
    v_lshlrev_b32 v58, 3, v58
    v_and_b32 v57, 15, v1
    v_sub_u32 v58, v58, v57
    v_add_u32 v58, 15, v58
    v_min_u32 v58, 31, v58
    s_mov_b32 s13, 0x10001
    s_mov_b32 s11, 469762048
    v_lshrrev_b32 v57, v58, s11
    v_and_b32 v57, 0xff, v57
    v_lshl_or_b32 v57, v57, 15, v57
    v_and_b32 v16, s13, v57
    v_mul_u32_u24 v16, 0x3f80, v16
    v_lshrrev_b32 v17, 2, v57
    v_and_b32 v17, s13, v17
    v_mul_u32_u24 v17, 0x3f80, v17
    v_lshrrev_b32 v18, 4, v57
    v_and_b32 v18, s13, v18
    v_mul_u32_u24 v18, 0x3f80, v18
    v_lshrrev_b32 v19, 6, v57
    v_and_b32 v19, s13, v19
    v_mul_u32_u24 v19, 0x3f80, v19
    s_mov_b32 s11, 65011712
    v_lshrrev_b32 v57, v58, s11
    v_and_b32 v57, 0xff, v57
    v_lshl_or_b32 v57, v57, 15, v57
    v_and_b32 v20, s13, v57
    v_mul_u32_u24 v20, 0x3f80, v20
    v_lshrrev_b32 v21, 2, v57
    v_and_b32 v21, s13, v21
    v_mul_u32_u24 v21, 0x3f80, v21
    v_lshrrev_b32 v22, 4, v57
    v_and_b32 v22, s13, v22
    v_mul_u32_u24 v22, 0x3f80, v22
    v_lshrrev_b32 v23, 6, v57
    v_and_b32 v23, s13, v23
    v_mul_u32_u24 v23, 0x3f80, v23
    s_mov_b32 s11, 1835008
    v_lshrrev_b32 v57, v58, s11
    v_and_b32 v57, 0xff, v57
    v_lshl_or_b32 v57, v57, 15, v57
    v_and_b32 v24, s13, v57
    v_mul_u32_u24 v24, 0x3f80, v24
    v_lshrrev_b32 v25, 2, v57
    v_and_b32 v25, s13, v25
    v_mul_u32_u24 v25, 0x3f80, v25
    v_lshrrev_b32 v26, 4, v57
    v_and_b32 v26, s13, v26
    v_mul_u32_u24 v26, 0x3f80, v26
    v_lshrrev_b32 v27, 6, v57
    v_and_b32 v27, s13, v27
    v_mul_u32_u24 v27, 0x3f80, v27
    s_mov_b32 s11, 133169152
    v_lshrrev_b32 v57, v58, s11
    v_and_b32 v57, 0xff, v57
    v_lshl_or_b32 v57, v57, 15, v57
    v_and_b32 v28, s13, v57
    v_mul_u32_u24 v28, 0x3f80, v28
    v_lshrrev_b32 v29, 2, v57
    v_and_b32 v29, s13, v29
    v_mul_u32_u24 v29, 0x3f80, v29
    v_lshrrev_b32 v30, 4, v57
    v_and_b32 v30, s13, v30
    v_mul_u32_u24 v30, 0x3f80, v30
    v_lshrrev_b32 v31, 6, v57
    v_and_b32 v31, s13, v31
    v_mul_u32_u24 v31, 0x3f80, v31
    s_mov_b32 s11, 267911168
    v_lshrrev_b32 v57, v58, s11
    v_and_b32 v57, 0xff, v57
    v_lshl_or_b32 v57, v57, 15, v57
    v_and_b32 v32, s13, v57
    v_mul_u32_u24 v32, 0x3f80, v32
    v_lshrrev_b32 v33, 2, v57
    v_and_b32 v33, s13, v33
    v_mul_u32_u24 v33, 0x3f80, v33
    v_lshrrev_b32 v34, 4, v57
    v_and_b32 v34, s13, v34
    v_mul_u32_u24 v34, 0x3f80, v34
    v_lshrrev_b32 v35, 6, v57
    v_and_b32 v35, s13, v35
    v_mul_u32_u24 v35, 0x3f80, v35
    s_mov_b32 s11, 402653184
    v_lshrrev_b32 v57, v58, s11
    v_and_b32 v57, 0xff, v57
    v_lshl_or_b32 v57, v57, 15, v57
    v_and_b32 v36, s13, v57
    v_mul_u32_u24 v36, 0x3f80, v36
    v_lshrrev_b32 v37, 2, v57
    v_and_b32 v37, s13, v37
    v_mul_u32_u24 v37, 0x3f80, v37
    v_lshrrev_b32 v38, 4, v57
    v_and_b32 v38, s13, v38
    v_mul_u32_u24 v38, 0x3f80, v38
    v_lshrrev_b32 v39, 6, v57
    v_and_b32 v39, s13, v39
    v_mul_u32_u24 v39, 0x3f80, v39
    ds_read2_b32 v[40:41], v2 offset0:24 offset1:25
    ds_read2_b32 v[42:43], v2 offset0:56 offset1:57
    ds_read2_b32 v[52:53], v2 offset0:88 offset1:89
    ds_read2_b32 v[54:55], v2 offset0:120 offset1:121
    ds_read2_b32 v[44:45], v2 offset0:16 offset1:17
    ds_read2_b32 v[46:47], v2 offset0:48 offset1:49
    ds_read2_b32 v[56:57], v2 offset0:80 offset1:81
    ds_read2_b32 v[58:59], v2 offset0:112 offset1:113
    ds_read2_b32 v[48:49], v2 offset0:8 offset1:9
    ds_read2_b32 v[50:51], v2 offset0:40 offset1:41
    ds_read2_b32 v[60:61], v2 offset0:72 offset1:73
    ds_read2_b32 v[62:63], v2 offset0:104 offset1:105
    ds_read2_b32 v[64:65], v2 offset0:160 offset1:161
    ds_read2_b32 v[66:67], v2 offset0:200 offset1:201
    ds_read2_b32 v[68:69], v2 offset0:152 offset1:153
    ds_read2_b32 v[70:71], v2 offset0:192 offset1:193
    ds_read2_b32 v[72:73], v2 offset0:144 offset1:145
    ds_read2_b32 v[74:75], v2 offset0:184 offset1:185
    ds_read2_b32 v[76:77], v2 offset0:136 offset1:137
    ds_read2_b32 v[78:79], v2 offset0:176 offset1:177
    ds_read2_b32 v[80:81], v2 offset0:216 offset1:217
    ds_read2_b32 v[208:209], v9 offset0:128 offset1:129
    ds_read2_b32 v[210:211], v9 offset0:130 offset1:131
    ds_read2_b32 v[212:213], v9 offset0:120 offset1:121
    ds_read2_b32 v[214:215], v9 offset0:122 offset1:123
    ds_read2_b32 v[216:217], v9 offset0:112 offset1:113
    ds_read2_b32 v[218:219], v9 offset0:114 offset1:115
    ds_read2_b32 v[220:221], v9 offset0:104 offset1:105
    ds_read2_b32 v[222:223], v9 offset0:106 offset1:107
    ds_read2_b32 v[224:225], v9 offset0:96 offset1:97
    ds_read2_b32 v[226:227], v9 offset0:98 offset1:99
    s_lshl_b32 s8, s39, 6
    v_lshrrev_b32 v82, 5, v1
    v_lshlrev_b32 v82, 3, v82
    v_sub_u32 v82, v10, v82
    v_add_u32 v82, s8, v82
    v_bfe_u32 v83, v1, 2, 2
    v_mul_u32_u24 v83, 20544, v83
    v_lshrrev_b32 v4, 4, v1
    v_lshl_add_u32 v83, v4, 5, v83
    v_and_b32 v4, 3, v1
    v_lshl_add_u32 v83, v4, 3, v83
    s_mul_i32 s9, s39, 1152
    s_add_u32 s9, s9, 10240
    v_add_u32 v83, s9, v83
    v_lshlrev_b32 v4, 4, v1
    v_mov_b32 v5, 1073741824
    v_cmp_eq_u32 vcc, 0, v1
    s_nop 1
    v_cndmask_b32 v5, v5, v1, vcc
    s_lshl_b32 s31, s58, 7
    s_add_u32 s31, s31, 8192000
    v_mov_b32 v12, -1
    v_mov_b32 v13, -1
    v_mov_b32 v14, -1
    v_mov_b32 v15, -1
    v_mov_b32 v105, s62
    v_lshlrev_b32 v104, 8, v1
    v_max_u32 v104, 4, v104
    s_mul_i32 s8, s37, 6554
    s_lshr_b32 s8, s8, 8
    s_lshl_b32 s9, s37, 8
    s_add_u32 s9, s9, 255
    s_mul_i32 s9, s9, 6554
    s_lshr_b32 s9, s9, 16
    s_sub_u32 s9, s9, s8
    s_add_u32 s9, s9, 1
    s_bfm_b32 s11, s9, 0
    s_lshl_b32 s8, s8, 8
    s_add_u32 s8, s8, 7471104
    s_mul_i32 s10, s37, 262144
    s_lshl_b32 s9, s38, 6
    s_add_u32 s10, s10, s9
    s_add_u32 s10, s10, 4194304
    s_mov_b32 s15, 0
    s_cmp_lg_u32 s39, 0
    s_cbranch_scc1 L_A_poll_done
    s_mov_b32 exec_hi, 0
    s_mov_b32 exec_lo, s11
L_A_poll:
    s_sleep 24
    buffer_load_dword v110, v104, s[16:19], s8 offen sc1
    s_add_u32 s15, s15, 1
    s_waitcnt vmcnt(0)
    v_cmp_ne_u32 vcc, s62, v110
    s_cmp_ge_u32 s15, 4000
    s_nop 3
    s_cbranch_scc1 L_A_poll_end
    s_cbranch_vccnz L_A_poll
L_A_poll_end:
    s_mov_b64 exec, -1
L_A_poll_done:
    s_barrier
    buffer_load_dwordx4 v[176:179], v109, s[16:19], s10 offen sc1
    s_add_u32 s10, s10, 65536
    buffer_load_dwordx4 v[180:183], v109, s[16:19], s10 offen sc1
    s_add_u32 s10, s10, 65536
    buffer_load_dwordx4 v[184:187], v109, s[16:19], s10 offen sc1
    s_add_u32 s10, s10, 65536
    buffer_load_dwordx4 v[188:191], v109, s[16:19], s10 offen sc1
    s_waitcnt vmcnt(3)
    ds_write_b128 v96, v[176:179] offset:1296
    s_waitcnt vmcnt(2)
    ds_write_b128 v96, v[180:183] offset:2448
    s_waitcnt vmcnt(1)
    ds_write_b128 v96, v[184:187] offset:3600
    s_waitcnt vmcnt(0)
    ds_write_b128 v96, v[188:191] offset:4752
    s_waitcnt lgkmcnt(0)
    s_barrier
    s_setprio 0
    ds_read_b128 v[236:239], v10 offset:1392
    ds_read_b128 v[240:243], v10 offset:1360
    ds_read_b128 v[244:247], v10 offset:1328
    ds_read_b128 v[248:251], v10 offset:1296
    ds_read_b128 v[84:87], v3 offset:1152
    ds_read_b128 v[88:91], v6 offset:1152
    s_waitcnt lgkmcnt(5)
    v_mfma_f32_32x32x16_bf16 v[192:207], v[208:211], v[236:239], 0
    ds_read_b128 v[92:95], v3 offset:1728
    ds_read_b128 v[96:99], v6 offset:1728
    ds_read_b128 v[100:103], v3 offset:2304
    ds_read_b128 v[104:107], v6 offset:2304
    s_waitcnt lgkmcnt(4)
    v_mfma_f32_16x16x32_bf16 v[132:135], v[84:87], v[16:19], 0
    v_mfma_f32_16x16x32_bf16 v[136:139], v[84:87], v[20:23], 0
    v_mfma_f32_16x16x32_bf16 v[140:143], v[84:87], v[24:27], 0
    ds_read_b128 v[252:255], v10 offset:1248
    v_mfma_f32_16x16x32_bf16 v[144:147], v[88:91], v[20:23], 0
    v_mfma_f32_16x16x32_bf16 v[148:151], v[84:87], v[28:31], 0
    v_mfma_f32_16x16x32_bf16 v[152:155], v[88:91], v[32:35], 0
    v_mfma_f32_32x32x16_bf16 v[192:207], v[212:215], v[240:243], v[192:207]
    v_mfma_f32_16x16x32_bf16 v[156:159], v[84:87], v[36:39], 0
    ds_read2_b32 v[228:229], v9 offset0:88 offset1:89
    ds_read2_b32 v[230:231], v9 offset0:90 offset1:91
    ds_read_b128 v[236:239], v10 offset:1216
    s_mov_b64 exec, 0xff
    buffer_store_dwordx4 v[12:15], v4, s[16:19], s31 offen sc1
    s_mov_b64 exec, -1
    ds_read_b128 v[84:87], v3 offset:2880
    ds_read_b128 v[88:91], v6 offset:2880
    v_mfma_f32_32x32x16_bf16 v[192:207], v[216:219], v[244:247], v[192:207]
    v_cvt_pk_bf16_f32 v160, v132, v133
    v_cvt_pk_bf16_f32 v161, v134, v135
    v_cvt_pk_bf16_f32 v162, v136, v137
    v_cvt_pk_bf16_f32 v163, v138, v139
    v_cvt_pk_bf16_f32 v164, v140, v141
    v_cvt_pk_bf16_f32 v165, v142, v143
    v_mfma_f32_32x32x16_bf16 v[176:191], v[208:211], v[244:247], 0
    ds_read2_b32 v[232:233], v9 offset0:80 offset1:81
    ds_read2_b32 v[234:235], v9 offset0:82 offset1:83
    ds_read_b128 v[240:243], v10 offset:1184
    v_cvt_pk_bf16_f32 v166, v144, v145
    v_cvt_pk_bf16_f32 v167, v146, v147
    v_mfma_f32_32x32x16_bf16 v[192:207], v[220:223], v[248:251], v[192:207]
    v_cvt_pk_bf16_f32 v168, v148, v149
    v_cvt_pk_bf16_f32 v169, v150, v151
    v_cvt_pk_bf16_f32 v170, v152, v153
    v_cvt_pk_bf16_f32 v171, v154, v155
    v_cvt_pk_bf16_f32 v172, v156, v157
    v_cvt_pk_bf16_f32 v173, v158, v159
    v_mfma_f32_32x32x16_bf16 v[176:191], v[212:215], v[248:251], v[176:191]
    ds_read2_b32 v[208:209], v9 offset0:72 offset1:73
    ds_read2_b32 v[210:211], v9 offset0:74 offset1:75
    ds_read_b128 v[244:247], v10 offset:1152
    s_waitcnt lgkmcnt(14)
    v_mfma_f32_16x16x32_bf16 v[132:135], v[92:95], v[16:19], 0
    v_mfma_f32_16x16x32_bf16 v[136:139], v[92:95], v[20:23], 0
    v_mfma_f32_16x16x32_bf16 v[140:143], v[92:95], v[24:27], 0
    s_waitcnt lgkmcnt(11)
    v_mfma_f32_32x32x16_bf16 v[192:207], v[224:227], v[252:255], v[192:207]
    v_mfma_f32_16x16x32_bf16 v[144:147], v[96:99], v[20:23], 0
    v_mfma_f32_16x16x32_bf16 v[148:151], v[92:95], v[28:31], 0
    v_mfma_f32_16x16x32_bf16 v[152:155], v[96:99], v[32:35], 0
    v_mfma_f32_32x32x16_bf16 v[176:191], v[216:219], v[252:255], v[176:191]
    ds_read2_b32 v[212:213], v9 offset0:64 offset1:65
    ds_read2_b32 v[214:215], v9 offset0:66 offset1:67
    ds_read_b128 v[248:251], v10 offset:1104
    v_mfma_f32_16x16x32_bf16 v[156:159], v[92:95], v[36:39], 0
    s_waitcnt lgkmcnt(11)
    v_mfma_f32_32x32x16_bf16 v[192:207], v[228:231], v[236:239], v[192:207]
    ds_read_b128 v[92:95], v3 offset:3456
    ds_read_b128 v[96:99], v6 offset:3456
    v_mfma_f32_16x16x16_bf16 v[116:119], v[172:173], v[80:81], 0
    v_mfma_f32_16x16x32_bf16 v[108:111], v[160:163], v[40:43], 0
    v_mfma_f32_16x16x32_bf16 v[108:111], v[164:167], v[52:55], v[108:111]
    v_mfma_f32_32x32x16_bf16 v[176:191], v[220:223], v[236:239], v[176:191]
    ds_read2_b32 v[216:217], v9 offset0:56 offset1:57
    ds_read2_b32 v[218:219], v9 offset0:58 offset1:59
    ds_read_b128 v[252:255], v10 offset:1072
    v_mfma_f32_16x16x32_bf16 v[112:115], v[160:163], v[44:47], 0
    v_mfma_f32_16x16x32_bf16 v[112:115], v[164:167], v[56:59], v[112:115]
    v_mfma_f32_16x16x32_bf16 v[128:131], v[168:171], v[76:79], 0
    s_waitcnt lgkmcnt(11)
    v_mfma_f32_32x32x16_bf16 v[192:207], v[232:235], v[240:243], v[192:207]
    v_mfma_f32_16x16x32_bf16 v[124:127], v[168:171], v[72:75], 0
    v_mfma_f32_16x16x32_bf16 v[120:123], v[168:171], v[68:71], 0
    v_mfma_f32_16x16x32_bf16 v[116:119], v[168:171], v[64:67], v[116:119]
    v_mfma_f32_32x32x16_bf16 v[176:191], v[224:227], v[240:243], v[176:191]
    ds_read2_b32 v[220:221], v9 offset0:48 offset1:49
    ds_read2_b32 v[222:223], v9 offset0:50 offset1:51
    ds_read_b128 v[236:239], v10 offset:1040
    v_mfma_f32_16x16x32_bf16 v[116:119], v[160:163], v[48:51], v[116:119]
    v_mfma_f32_16x16x32_bf16 v[116:119], v[164:167], v[60:63], v[116:119]
    s_waitcnt lgkmcnt(11)
    v_mfma_f32_32x32x16_bf16 v[192:207], v[208:211], v[244:247], v[192:207]
    v_cvt_pk_bf16_f32 v160, v132, v133
    v_cvt_pk_bf16_f32 v161, v134, v135
    v_cvt_pk_bf16_f32 v162, v136, v137
    v_cvt_pk_bf16_f32 v163, v138, v139
    v_cvt_pk_bf16_f32 v164, v140, v141
    v_cvt_pk_bf16_f32 v165, v142, v143
    v_mfma_f32_32x32x16_bf16 v[176:191], v[228:231], v[244:247], v[176:191]
    ds_read2_b32 v[224:225], v9 offset0:40 offset1:41
    ds_read2_b32 v[226:227], v9 offset0:42 offset1:43
    ds_read_b128 v[240:243], v10 offset:1008
    v_cvt_pk_bf16_f32 v166, v144, v145
    v_cvt_pk_bf16_f32 v167, v146, v147
    s_waitcnt lgkmcnt(11)
    v_mfma_f32_32x32x16_bf16 v[192:207], v[212:215], v[248:251], v[192:207]
    v_cvt_pk_bf16_f32 v168, v148, v149
    v_cvt_pk_bf16_f32 v169, v150, v151
    v_cvt_pk_bf16_f32 v170, v152, v153
    v_cvt_pk_bf16_f32 v171, v154, v155
    v_cvt_pk_bf16_f32 v172, v156, v157
    v_cvt_pk_bf16_f32 v173, v158, v159
    v_mfma_f32_32x32x16_bf16 v[176:191], v[232:235], v[248:251], v[176:191]
    ds_read2_b32 v[228:229], v9 offset0:32 offset1:33
    ds_read2_b32 v[230:231], v9 offset0:34 offset1:35
    ds_read_b128 v[244:247], v10 offset:960
    v_mfma_f32_16x16x32_bf16 v[132:135], v[100:103], v[16:19], 0
    v_mfma_f32_16x16x32_bf16 v[136:139], v[100:103], v[20:23], 0
    v_mfma_f32_16x16x32_bf16 v[140:143], v[100:103], v[24:27], 0
    s_waitcnt lgkmcnt(9)
    v_mfma_f32_32x32x16_bf16 v[192:207], v[216:219], v[252:255], v[192:207]
    v_mfma_f32_16x16x32_bf16 v[144:147], v[104:107], v[20:23], 0
    v_mfma_f32_16x16x32_bf16 v[148:151], v[100:103], v[28:31], 0
    v_mfma_f32_16x16x32_bf16 v[152:155], v[104:107], v[32:35], 0
    v_mfma_f32_32x32x16_bf16 v[176:191], v[208:211], v[252:255], v[176:191]
    ds_read2_b32 v[232:233], v9 offset0:24 offset1:25
    ds_read2_b32 v[234:235], v9 offset0:26 offset1:27
    ds_read_b128 v[248:251], v10 offset:928
    v_mfma_f32_16x16x32_bf16 v[156:159], v[100:103], v[36:39], 0
    s_waitcnt lgkmcnt(9)
    v_mfma_f32_32x32x16_bf16 v[192:207], v[220:223], v[236:239], v[192:207]
    ds_read_b128 v[100:103], v3 offset:4032
    ds_read_b128 v[104:107], v6 offset:4032
    v_mfma_f32_16x16x16_bf16 v[120:123], v[172:173], v[80:81], v[120:123]
    v_mfma_f32_16x16x32_bf16 v[112:115], v[160:163], v[40:43], v[112:115]
    v_mfma_f32_16x16x32_bf16 v[112:115], v[164:167], v[52:55], v[112:115]
    v_mfma_f32_32x32x16_bf16 v[176:191], v[212:215], v[236:239], v[176:191]
    ds_read2_b32 v[208:209], v9 offset0:16 offset1:17
    ds_read2_b32 v[210:211], v9 offset0:18 offset1:19
    ds_read_b128 v[252:255], v10 offset:896
    v_mfma_f32_16x16x32_bf16 v[116:119], v[160:163], v[44:47], v[116:119]
    v_mfma_f32_16x16x32_bf16 v[116:119], v[164:167], v[56:59], v[116:119]
    v_mfma_f32_16x16x32_bf16 v[128:131], v[168:171], v[72:75], v[128:131]
    s_waitcnt lgkmcnt(11)
    v_mfma_f32_32x32x16_bf16 v[192:207], v[224:227], v[240:243], v[192:207]
    v_mfma_f32_16x16x32_bf16 v[124:127], v[168:171], v[68:71], v[124:127]
    v_mfma_f32_16x16x32_bf16 v[120:123], v[168:171], v[64:67], v[120:123]
    v_mfma_f32_16x16x32_bf16 v[120:123], v[160:163], v[48:51], v[120:123]
    v_mfma_f32_32x32x16_bf16 v[176:191], v[216:219], v[240:243], v[176:191]
    ds_read2_b32 v[212:213], v9 offset0:8 offset1:9
    ds_read2_b32 v[214:215], v9 offset0:10 offset1:11
    ds_read_b128 v[236:239], v10 offset:864
    v_mfma_f32_16x16x32_bf16 v[120:123], v[164:167], v[60:63], v[120:123]
    s_waitcnt lgkmcnt(11)
    v_mfma_f32_32x32x16_bf16 v[192:207], v[228:231], v[244:247], v[192:207]
    v_cvt_pk_bf16_f32 v160, v132, v133
    v_cvt_pk_bf16_f32 v161, v134, v135
    v_cvt_pk_bf16_f32 v162, v136, v137
    v_cvt_pk_bf16_f32 v163, v138, v139
    v_cvt_pk_bf16_f32 v164, v140, v141
    v_cvt_pk_bf16_f32 v165, v142, v143
    v_mfma_f32_32x32x16_bf16 v[176:191], v[220:223], v[244:247], v[176:191]
    ds_read2_b32 v[216:217], v9 offset0:0 offset1:1
    ds_read2_b32 v[218:219], v9 offset0:2 offset1:3
    ds_read_b128 v[240:243], v10 offset:816
    v_cvt_pk_bf16_f32 v166, v144, v145
    v_cvt_pk_bf16_f32 v167, v146, v147
    s_waitcnt lgkmcnt(11)
    v_mfma_f32_32x32x16_bf16 v[192:207], v[232:235], v[248:251], v[192:207]
    v_cvt_pk_bf16_f32 v168, v148, v149
    v_cvt_pk_bf16_f32 v169, v150, v151
    v_cvt_pk_bf16_f32 v170, v152, v153
    v_cvt_pk_bf16_f32 v171, v154, v155
    v_cvt_pk_bf16_f32 v172, v156, v157
    v_cvt_pk_bf16_f32 v173, v158, v159
    v_mfma_f32_32x32x16_bf16 v[176:191], v[224:227], v[248:251], v[176:191]
    ds_read2_b32 v[220:221], v8 offset0:136 offset1:137
    ds_read2_b32 v[222:223], v8 offset0:138 offset1:139
    ds_read_b128 v[244:247], v10 offset:784
    v_mfma_f32_16x16x32_bf16 v[132:135], v[84:87], v[16:19], 0
    v_mfma_f32_16x16x32_bf16 v[136:139], v[84:87], v[20:23], 0
    v_mfma_f32_16x16x32_bf16 v[140:143], v[84:87], v[24:27], 0
    s_waitcnt lgkmcnt(9)
    v_mfma_f32_32x32x16_bf16 v[192:207], v[208:211], v[252:255], v[192:207]
    v_mfma_f32_16x16x32_bf16 v[144:147], v[88:91], v[20:23], 0
    v_mfma_f32_16x16x32_bf16 v[148:151], v[84:87], v[28:31], 0
    v_mfma_f32_16x16x32_bf16 v[152:155], v[88:91], v[32:35], 0
    v_mfma_f32_32x32x16_bf16 v[176:191], v[228:231], v[252:255], v[176:191]
    ds_read2_b32 v[224:225], v8 offset0:128 offset1:129
    ds_read2_b32 v[226:227], v8 offset0:130 offset1:131
    ds_read_b128 v[248:251], v10 offset:752
    v_mfma_f32_16x16x32_bf16 v[156:159], v[84:87], v[36:39], 0
    v_mfma_f32_16x16x16_bf16 v[124:127], v[172:173], v[80:81], v[124:127]
    v_mfma_f32_16x16x32_bf16 v[116:119], v[160:163], v[40:43], v[116:119]
    s_waitcnt lgkmcnt(9)
    v_mfma_f32_32x32x16_bf16 v[192:207], v[212:215], v[236:239], v[192:207]
    v_mfma_f32_16x16x32_bf16 v[116:119], v[164:167], v[52:55], v[116:119]
    v_mfma_f32_16x16x32_bf16 v[120:123], v[160:163], v[44:47], v[120:123]
    v_mfma_f32_16x16x32_bf16 v[120:123], v[164:167], v[56:59], v[120:123]
    v_mfma_f32_32x32x16_bf16 v[176:191], v[232:235], v[236:239], v[176:191]
    ds_read2_b32 v[228:229], v8 offset0:120 offset1:121
    ds_read2_b32 v[230:231], v8 offset0:122 offset1:123
    ds_read_b128 v[252:255], v10 offset:720
    v_mfma_f32_16x16x32_bf16 v[128:131], v[168:171], v[68:71], v[128:131]
    v_mfma_f32_16x16x32_bf16 v[124:127], v[168:171], v[64:67], v[124:127]
    v_mfma_f32_16x16x32_bf16 v[124:127], v[160:163], v[48:51], v[124:127]
    s_waitcnt lgkmcnt(9)
    v_mfma_f32_32x32x16_bf16 v[192:207], v[216:219], v[240:243], v[192:207]
    v_mfma_f32_16x16x32_bf16 v[124:127], v[164:167], v[60:63], v[124:127]
    v_mfma_f32_32x32x16_bf16 v[176:191], v[208:211], v[240:243], v[176:191]
    ds_read2_b32 v[232:233], v8 offset0:112 offset1:113
    ds_read2_b32 v[234:235], v8 offset0:114 offset1:115
    ds_read_b128 v[236:239], v10 offset:672
    v_cvt_pk_bf16_f32 v160, v132, v133
    v_cvt_pk_bf16_f32 v161, v134, v135
    s_waitcnt lgkmcnt(9)
    v_mfma_f32_32x32x16_bf16 v[192:207], v[220:223], v[244:247], v[192:207]
    v_cvt_pk_bf16_f32 v162, v136, v137
    v_cvt_pk_bf16_f32 v163, v138, v139
    v_cvt_pk_bf16_f32 v164, v140, v141
    v_cvt_pk_bf16_f32 v165, v142, v143
    v_cvt_pk_bf16_f32 v166, v144, v145
    v_cvt_pk_bf16_f32 v167, v146, v147
    v_mfma_f32_32x32x16_bf16 v[176:191], v[212:215], v[244:247], v[176:191]
    ds_read2_b32 v[208:209], v8 offset0:104 offset1:105
    ds_read2_b32 v[210:211], v8 offset0:106 offset1:107
    ds_read_b128 v[240:243], v10 offset:640
    v_cvt_pk_bf16_f32 v168, v148, v149
    v_cvt_pk_bf16_f32 v169, v150, v151
    s_waitcnt lgkmcnt(9)
    v_mfma_f32_32x32x16_bf16 v[192:207], v[224:227], v[248:251], v[192:207]
    v_cvt_pk_bf16_f32 v170, v152, v153
    v_cvt_pk_bf16_f32 v171, v154, v155
    v_cvt_pk_bf16_f32 v172, v156, v157
    v_cvt_pk_bf16_f32 v173, v158, v159
    v_mfma_f32_16x16x32_bf16 v[132:135], v[92:95], v[16:19], 0
    v_mfma_f32_16x16x32_bf16 v[136:139], v[92:95], v[20:23], 0
    v_mfma_f32_16x16x32_bf16 v[140:143], v[92:95], v[24:27], 0
    v_mfma_f32_32x32x16_bf16 v[176:191], v[216:219], v[248:251], v[176:191]
    ds_read2_b32 v[212:213], v8 offset0:96 offset1:97
    ds_read2_b32 v[214:215], v8 offset0:98 offset1:99
    ds_read_b128 v[244:247], v10 offset:608
    v_mfma_f32_16x16x32_bf16 v[144:147], v[96:99], v[20:23], 0
    v_mfma_f32_16x16x16_bf16 v[128:131], v[172:173], v[80:81], v[128:131]
    v_mfma_f32_16x16x32_bf16 v[120:123], v[160:163], v[40:43], v[120:123]
    s_waitcnt lgkmcnt(9)
    v_mfma_f32_32x32x16_bf16 v[192:207], v[228:231], v[252:255], v[192:207]
    v_mfma_f32_16x16x32_bf16 v[120:123], v[164:167], v[52:55], v[120:123]
    v_mfma_f32_16x16x32_bf16 v[124:127], v[160:163], v[44:47], v[124:127]
    v_mfma_f32_16x16x32_bf16 v[124:127], v[164:167], v[56:59], v[124:127]
    v_mfma_f32_32x32x16_bf16 v[176:191], v[220:223], v[252:255], v[176:191]
    ds_read2_b32 v[216:217], v8 offset0:88 offset1:89
    ds_read2_b32 v[218:219], v8 offset0:90 offset1:91
    ds_read_b128 v[248:251], v10 offset:576
    v_mfma_f32_16x16x32_bf16 v[128:131], v[168:171], v[64:67], v[128:131]
    v_mfma_f32_16x16x32_bf16 v[128:131], v[160:163], v[48:51], v[128:131]
    v_mfma_f32_16x16x32_bf16 v[128:131], v[164:167], v[60:63], v[128:131]
    s_waitcnt lgkmcnt(9)
    v_mfma_f32_32x32x16_bf16 v[192:207], v[232:235], v[236:239], v[192:207]
    v_cvt_pk_bf16_f32 v160, v132, v133
    v_cvt_pk_bf16_f32 v161, v134, v135
    v_cvt_pk_bf16_f32 v162, v136, v137
    v_cvt_pk_bf16_f32 v163, v138, v139
    v_cvt_pk_bf16_f32 v164, v140, v141
    v_cvt_pk_bf16_f32 v165, v142, v143
    v_mfma_f32_32x32x16_bf16 v[176:191], v[224:227], v[236:239], v[176:191]
    ds_read2_b32 v[220:221], v8 offset0:80 offset1:81
    ds_read2_b32 v[222:223], v8 offset0:82 offset1:83
    ds_read_b128 v[252:255], v10 offset:528
    v_cvt_pk_bf16_f32 v166, v144, v145
    v_cvt_pk_bf16_f32 v167, v146, v147
    s_waitcnt lgkmcnt(9)
    v_mfma_f32_32x32x16_bf16 v[192:207], v[208:211], v[240:243], v[192:207]
    v_mfma_f32_16x16x32_bf16 v[132:135], v[100:103], v[16:19], 0
    v_mfma_f32_16x16x32_bf16 v[136:139], v[100:103], v[20:23], 0
    v_mfma_f32_16x16x32_bf16 v[140:143], v[100:103], v[24:27], 0
    v_mfma_f32_32x32x16_bf16 v[176:191], v[228:231], v[240:243], v[176:191]
    ds_read2_b32 v[224:225], v8 offset0:72 offset1:73
    ds_read2_b32 v[226:227], v8 offset0:74 offset1:75
    ds_read_b128 v[236:239], v10 offset:496
    v_mfma_f32_16x16x32_bf16 v[144:147], v[104:107], v[20:23], 0
    v_mfma_f32_16x16x32_bf16 v[124:127], v[160:163], v[40:43], v[124:127]
    v_mfma_f32_16x16x32_bf16 v[124:127], v[164:167], v[52:55], v[124:127]
    s_waitcnt lgkmcnt(9)
    v_mfma_f32_32x32x16_bf16 v[192:207], v[212:215], v[244:247], v[192:207]
    v_mfma_f32_16x16x32_bf16 v[128:131], v[160:163], v[44:47], v[128:131]
    v_mfma_f32_16x16x32_bf16 v[128:131], v[164:167], v[56:59], v[128:131]
    v_mfma_f32_32x32x16_bf16 v[176:191], v[232:235], v[244:247], v[176:191]
    ds_read2_b32 v[228:229], v8 offset0:64 offset1:65
    ds_read2_b32 v[230:231], v8 offset0:66 offset1:67
    ds_read_b128 v[240:243], v10 offset:464
    v_cvt_pk_bf16_f32 v160, v132, v133
    v_cvt_pk_bf16_f32 v161, v134, v135
    s_waitcnt lgkmcnt(9)
    v_mfma_f32_32x32x16_bf16 v[192:207], v[216:219], v[248:251], v[192:207]
    v_cvt_pk_bf16_f32 v162, v136, v137
    v_cvt_pk_bf16_f32 v163, v138, v139
    v_cvt_pk_bf16_f32 v164, v140, v141
    v_cvt_pk_bf16_f32 v165, v142, v143
    v_cvt_pk_bf16_f32 v166, v144, v145
    v_cvt_pk_bf16_f32 v167, v146, v147
    v_mfma_f32_16x16x32_bf16 v[128:131], v[160:163], v[40:43], v[128:131]
    s_nop 0
    v_mfma_f32_16x16x32_bf16 v[128:131], v[164:167], v[52:55], v[128:131]
    v_mfma_f32_32x32x16_bf16 v[176:191], v[208:211], v[248:251], v[176:191]
    ds_read2_b32 v[232:233], v8 offset0:56 offset1:57
    ds_read2_b32 v[234:235], v8 offset0:58 offset1:59
    ds_read_b128 v[244:247], v10 offset:432
    s_nop 3
    s_waitcnt lgkmcnt(9)
    v_mfma_f32_32x32x16_bf16 v[192:207], v[220:223], v[252:255], v[192:207]
    ds_write_b128 v7, v[108:111] offset:12416
    ds_write_b128 v7, v[112:115] offset:13504
    ds_write_b128 v7, v[116:119] offset:14592
    v_mfma_f32_32x32x16_bf16 v[176:191], v[212:215], v[252:255], v[176:191]
    ds_read2_b32 v[208:209], v8 offset0:48 offset1:49
    ds_read2_b32 v[210:211], v8 offset0:50 offset1:51
    ds_read_b128 v[248:251], v10 offset:384
    ds_write_b128 v7, v[120:123] offset:15680
    s_waitcnt lgkmcnt(13)
    v_mfma_f32_32x32x16_bf16 v[192:207], v[224:227], v[236:239], v[192:207]
    ds_write_b128 v7, v[124:127] offset:16768
    ds_write_b128 v7, v[128:131] offset:17856
    ds_read_b128 v[40:43], v11 offset:10240
    v_mfma_f32_32x32x16_bf16 v[176:191], v[216:219], v[236:239], v[176:191]
    ds_read2_b32 v[212:213], v8 offset0:40 offset1:41
    ds_read2_b32 v[214:215], v8 offset0:42 offset1:43
    ds_read_b128 v[252:255], v10 offset:352
    ds_read_b128 v[44:47], v11 offset:10272
    s_waitcnt lgkmcnt(15)
    v_mfma_f32_32x32x16_bf16 v[192:207], v[228:231], v[240:243], v[192:207]
    ds_read_b128 v[48:51], v11 offset:10304
    ds_read_b128 v[52:55], v11 offset:10336
    ds_read_b128 v[56:59], v11 offset:10368
    v_mfma_f32_32x32x16_bf16 v[176:191], v[220:223], v[240:243], v[176:191]
    ds_read2_b32 v[216:217], v8 offset0:32 offset1:33
    ds_read2_b32 v[218:219], v8 offset0:34 offset1:35
    ds_read_b128 v[236:239], v10 offset:320
    ds_read_b128 v[60:63], v11 offset:10400
    s_waitcnt lgkmcnt(15)
    v_mfma_f32_32x32x16_bf16 v[192:207], v[232:235], v[244:247], v[192:207]
    ds_read_b128 v[64:67], v11 offset:10432
    ds_read_b128 v[68:71], v11 offset:10464
    v_mfma_f32_32x32x16_bf16 v[176:191], v[224:227], v[244:247], v[176:191]
    ds_read2_b32 v[220:221], v8 offset0:24 offset1:25
    ds_read2_b32 v[222:223], v8 offset0:26 offset1:27
    ds_read_b128 v[240:243], v10 offset:288
    v_mfma_f32_32x32x16_bf16 v[192:207], v[208:211], v[248:251], v[192:207]
    v_mfma_f32_32x32x16_bf16 v[176:191], v[228:231], v[248:251], v[176:191]
    ds_read2_b32 v[224:225], v8 offset0:16 offset1:17
    ds_read2_b32 v[226:227], v8 offset0:18 offset1:19
    ds_read_b128 v[244:247], v10 offset:240
    s_waitcnt lgkmcnt(15)
    v_mfma_f32_32x32x16_bf16 v[192:207], v[212:215], v[252:255], v[192:207]
    v_mfma_f32_32x32x16_bf16 v[176:191], v[232:235], v[252:255], v[176:191]
    ds_read2_b32 v[228:229], v8 offset0:8 offset1:9
    ds_read2_b32 v[230:231], v8 offset0:10 offset1:11
    ds_read_b128 v[248:251], v10 offset:208
    s_waitcnt lgkmcnt(12)
    v_mfma_f32_32x32x16_bf16 v[192:207], v[216:219], v[236:239], v[192:207]
    v_mfma_f32_32x32x16_bf16 v[176:191], v[208:211], v[236:239], v[176:191]
    ds_read2_b32 v[232:233], v8 offset0:0 offset1:1
    ds_read2_b32 v[234:235], v8 offset0:2 offset1:3
    ds_read_b128 v[252:255], v10 offset:176
    s_waitcnt lgkmcnt(9)
    v_mfma_f32_32x32x16_bf16 v[192:207], v[220:223], v[240:243], v[192:207]
    v_mfma_f32_32x32x16_bf16 v[176:191], v[212:215], v[240:243], v[176:191]
    ds_read_b128 v[236:239], v10 offset:144
    s_waitcnt lgkmcnt(7)
    v_mfma_f32_32x32x16_bf16 v[192:207], v[224:227], v[244:247], v[192:207]
    v_mfma_f32_32x32x16_bf16 v[176:191], v[216:219], v[244:247], v[176:191]
    ds_read_b128 v[240:243], v10 offset:96
    s_waitcnt lgkmcnt(5)
    v_mfma_f32_32x32x16_bf16 v[192:207], v[228:231], v[248:251], v[192:207]
    v_mfma_f32_32x32x16_bf16 v[176:191], v[220:223], v[248:251], v[176:191]
    s_waitcnt lgkmcnt(2)
    v_mfma_f32_32x32x16_bf16 v[192:207], v[232:235], v[252:255], v[192:207]
    v_mfma_f32_32x32x16_bf16 v[176:191], v[224:227], v[252:255], v[176:191]
    s_waitcnt lgkmcnt(1)
    v_mfma_f32_32x32x16_bf16 v[176:191], v[228:231], v[236:239], v[176:191]
    s_waitcnt lgkmcnt(0)
    v_mfma_f32_32x32x16_bf16 v[176:191], v[232:235], v[240:243], v[176:191]
    s_setprio 3
    v_mov_b32 v13, s62
    v_mov_b32 v7, v4
    s_waitcnt lgkmcnt(0)
    s_nop 2
    v_add_f32 v192, v192, v56
    v_add_f32 v193, v193, v57
    v_add_f32 v194, v194, v58
    v_add_f32 v195, v195, v59
    v_cvt_pk_bf16_f32 v92, v192, v193
    v_cvt_pk_bf16_f32 v93, v194, v195
    ds_write_b64 v82, v[92:93] offset:10304
    v_add_f32 v196, v196, v60
    v_add_f32 v197, v197, v61
    v_add_f32 v198, v198, v62
    v_add_f32 v199, v199, v63
    v_cvt_pk_bf16_f32 v94, v196, v197
    v_cvt_pk_bf16_f32 v95, v198, v199
    ds_write_b64 v82, v[94:95] offset:10320
    v_add_f32 v200, v200, v64
    v_add_f32 v201, v201, v65
    v_add_f32 v202, v202, v66
    v_add_f32 v203, v203, v67
    v_cvt_pk_bf16_f32 v96, v200, v201
    v_cvt_pk_bf16_f32 v97, v202, v203
    ds_write_b64 v82, v[96:97] offset:10336
    v_add_f32 v204, v204, v68
    v_add_f32 v205, v205, v69
    v_add_f32 v206, v206, v70
    v_add_f32 v207, v207, v71
    v_cvt_pk_bf16_f32 v98, v204, v205
    v_cvt_pk_bf16_f32 v99, v206, v207
    ds_write_b64 v82, v[98:99] offset:10352
    v_add_f32 v176, v176, v40
    v_add_f32 v177, v177, v41
    v_add_f32 v178, v178, v42
    v_add_f32 v179, v179, v43
    v_cvt_pk_bf16_f32 v84, v176, v177
    v_cvt_pk_bf16_f32 v85, v178, v179
    ds_write_b64 v82, v[84:85] offset:10240
    v_add_f32 v180, v180, v44
    v_add_f32 v181, v181, v45
    v_add_f32 v182, v182, v46
    v_add_f32 v183, v183, v47
    v_cvt_pk_bf16_f32 v86, v180, v181
    v_cvt_pk_bf16_f32 v87, v182, v183
    ds_write_b64 v82, v[86:87] offset:10256
    v_add_f32 v184, v184, v48
    v_add_f32 v185, v185, v49
    v_add_f32 v186, v186, v50
    v_add_f32 v187, v187, v51
    v_cvt_pk_bf16_f32 v88, v184, v185
    v_cvt_pk_bf16_f32 v89, v186, v187
    ds_write_b64 v82, v[88:89] offset:10272
    v_add_f32 v188, v188, v52
    v_add_f32 v189, v189, v53
    v_add_f32 v190, v190, v54
    v_add_f32 v191, v191, v55
    v_cvt_pk_bf16_f32 v90, v188, v189
    v_cvt_pk_bf16_f32 v91, v190, v191
    ds_write_b64 v82, v[90:91] offset:10288
    s_waitcnt vmcnt(0) lgkmcnt(0)
    s_barrier
    ds_read_b64_tr_b16 v[40:41], v83 offset:0
    ds_read_b64_tr_b16 v[42:43], v83 offset:144
    ds_read_b64_tr_b16 v[44:45], v83 offset:288
    ds_read_b64_tr_b16 v[46:47], v83 offset:432
    ds_read_b64_tr_b16 v[48:49], v83 offset:576
    ds_read_b64_tr_b16 v[50:51], v83 offset:720
    ds_read_b64_tr_b16 v[52:53], v83 offset:864
    ds_read_b64_tr_b16 v[54:55], v83 offset:1008
    s_add_u32 s12, s35, 0
    s_waitcnt lgkmcnt(6)
    buffer_store_dwordx4 v[40:43], v7, s[16:19], s12 offen sc1
    s_add_u32 s12, s35, 16384
    s_waitcnt lgkmcnt(4)
    buffer_store_dwordx4 v[44:47], v7, s[16:19], s12 offen sc1
    s_add_u32 s12, s35, 32768
    s_waitcnt lgkmcnt(2)
    buffer_store_dwordx4 v[48:51], v7, s[16:19], s12 offen sc1
    s_add_u32 s12, s35, 49152
    s_waitcnt lgkmcnt(0)
    buffer_store_dwordx4 v[52:55], v7, s[16:19], s12 offen sc1
    s_waitcnt vmcnt(0)
    buffer_store_dword v13, v5, s[16:19], s31 offen sc1
    s_mul_i32 s8, s37, 262144
    s_mul_i32 s9, s38, 16384
    s_add_u32 s8, s8, s9
    s_lshl_b32 s9, s39, 12
    s_add_u32 s8, s8, s9
    s_add_u32 s8, s8, 12582912
    v_lshrrev_b32 v2, 5, v1
    v_mul_u32_u24 v2, 20480, v2
    v_and_b32 v3, 31, v1
    v_mul_u32_u24 v3, 144, v3
    s_lshl_b32 s9, s39, 5
    v_add3_u32 v2, v2, v3, s9
    v_lshrrev_b32 v3, 3, v1
    v_mul_u32_u24 v4, 144, v3
    v_and_b32 v5, 7, v1
    v_lshl_add_u32 v4, v5, 4, v4
    v_add_u32 v4, s59, v4
    v_mul_u32_u24 v3, 2560, v3
    v_lshl_add_u32 v3, v5, 4, v3
    s_lshl_b32 s10, s38, 2
    s_add_u32 s10, s10, s39
    s_mul_i32 s10, s10, 81920
    s_lshl_b32 s11, s37, 7
    s_add_u32 s10, s10, s11
    s_mov_b32 s15, 0
    v_lshlrev_b32 v10, 9, v1
    s_lshl_b32 s12, s37, 6
    s_lshl_b32 s13, s39, 4
    s_add_u32 s12, s12, s13
    s_lshr_b32 s13, s38, 2
    s_add_u32 s12, s12, s13
    s_lshl_b32 s12, s12, 7
    s_add_u32 s12, s12, 8192000
L_A_ys:
    s_mov_b64 exec, 15
    buffer_load_dword v11, v10, s[16:19], s12 offen sc1
    s_add_u32 s15, s15, 1
    s_waitcnt vmcnt(0)
    v_cmp_ne_u32 vcc, s62, v11
    s_mov_b64 exec, -1
    s_cmp_ge_u32 s15, 4000
    s_nop 2
    s_cbranch_scc1 L_A_y
    s_cbranch_vccz L_A_y
    s_sleep 2
    s_branch L_A_ys
L_A_y:
    buffer_load_dwordx4 v[56:59], v7, s[16:19], s8 offen offset:0 sc1
    buffer_load_dwordx4 v[60:63], v7, s[16:19], s8 offen offset:1024 sc1
    buffer_load_dwordx4 v[64:67], v7, s[16:19], s8 offen offset:2048 sc1
    buffer_load_dwordx4 v[68:71], v7, s[16:19], s8 offen offset:3072 sc1
    s_add_u32 s15, s15, 1
    s_waitcnt vmcnt(0)
    v_max3_u32 v8, v56, v57, v58
    v_max3_u32 v9, v59, v60, v61
    v_max3_u32 v8, v8, v62, v63
    v_max3_u32 v9, v9, v64, v65
    v_max3_u32 v8, v8, v66, v67
    v_max3_u32 v9, v9, v68, v69
    v_max3_u32 v8, v8, v70, v71
    v_max_u32 v8, v8, v9
    v_cmp_eq_u32 vcc, -1, v8
    s_cmp_ge_u32 s15, 4000
    s_nop 3
    s_cbranch_scc1 L_A_y_done
    s_cbranch_vccz L_A_y_done
    s_sleep 4
    s_branch L_A_y
L_A_y_done:
    ds_write_b64 v2, v[56:57] offset:0
    ds_write_b64 v2, v[58:59] offset:40960
    ds_write_b64 v2, v[60:61] offset:8
    ds_write_b64 v2, v[62:63] offset:40968
    ds_write_b64 v2, v[64:65] offset:16
    ds_write_b64 v2, v[66:67] offset:40976
    ds_write_b64 v2, v[68:69] offset:24
    ds_write_b64 v2, v[70:71] offset:40984
    s_waitcnt lgkmcnt(0)
    s_barrier
    ds_read_b128 v[40:43], v4 offset:0
    ds_read_b128 v[44:47], v4 offset:1152
    ds_read_b128 v[48:51], v4 offset:2304
    ds_read_b128 v[52:55], v4 offset:3456
    s_waitcnt lgkmcnt(3)
    buffer_store_dwordx4 v[40:43], v3, s[20:23], s10 offen
    s_add_u32 s10, s10, 20480
    s_waitcnt lgkmcnt(2)
    buffer_store_dwordx4 v[44:47], v3, s[20:23], s10 offen
    s_add_u32 s10, s10, 20480
    s_waitcnt lgkmcnt(1)
    buffer_store_dwordx4 v[48:51], v3, s[20:23], s10 offen
    s_add_u32 s10, s10, 20480
    s_waitcnt lgkmcnt(0)
    buffer_store_dwordx4 v[52:55], v3, s[20:23], s10 offen
    s_cmp_lg_u32 s38, 0
    s_nop 0
    s_cbranch_scc1 L_A_fin
    v_mov_b32 v1, 1073741824
    v_cmp_eq_u32 vcc, 0, v0
    s_nop 1
    v_cndmask_b32 v1, v1, v0, vcc
    v_mov_b32 v2, s62
    buffer_store_dword v2, v1, s[16:19], s34 offen sc1
    s_nop 0
L_A_fin:
L_A_end:
    s_endpgm
L_B_fix0:
    s_lshl_b32 s43, s28, 12
    s_add_u32 s43, s43, s3
    s_add_u32 s43, s43, 0
    buffer_load_dwordx4 v[36:39], v2, s[16:19], s43 offen sc1
    s_add_u32 s52, s52, 1
    s_waitcnt vmcnt(0)
    v_max3_u32 v13, v36, v37, v38
    v_max_u32 v13, v13, v39
    v_cmp_eq_u32 vcc, -1, v13
    s_cmp_ge_u32 s52, 4000
    s_nop 3
    s_cbranch_scc1 L_B_ok0
    s_cbranch_vccnz L_B_fix0
    s_branch L_B_ok0
L_B_fix1:
    s_lshl_b32 s43, s28, 12
    s_add_u32 s43, s43, s3
    s_add_u32 s43, s43, 1024
    buffer_load_dwordx4 v[40:43], v2, s[16:19], s43 offen sc1
    s_add_u32 s52, s52, 1
    s_waitcnt vmcnt(0)
    v_max3_u32 v13, v40, v41, v42
    v_max_u32 v13, v13, v43
    v_cmp_eq_u32 vcc, -1, v13
    s_cmp_ge_u32 s52, 4000
    s_nop 3
    s_cbranch_scc1 L_B_ok1
    s_cbranch_vccnz L_B_fix1
    s_branch L_B_ok1
L_B_fix2:
    s_lshl_b32 s43, s28, 12
    s_add_u32 s43, s43, s3
    s_add_u32 s43, s43, 2048
    buffer_load_dwordx4 v[44:47], v2, s[16:19], s43 offen sc1
    s_add_u32 s52, s52, 1
    s_waitcnt vmcnt(0)
    v_max3_u32 v13, v44, v45, v46
    v_max_u32 v13, v13, v47
    v_cmp_eq_u32 vcc, -1, v13
    s_cmp_ge_u32 s52, 4000
    s_nop 3
    s_cbranch_scc1 L_B_ok2
    s_cbranch_vccnz L_B_fix2
    s_branch L_B_ok2
L_B_fix3:
    s_lshl_b32 s43, s28, 12
    s_add_u32 s43, s43, s3
    s_add_u32 s43, s43, 3072
    buffer_load_dwordx4 v[48:51], v2, s[16:19], s43 offen sc1
    s_add_u32 s52, s52, 1
    s_waitcnt vmcnt(0)
    v_max3_u32 v13, v48, v49, v50
    v_max_u32 v13, v13, v51
    v_cmp_eq_u32 vcc, -1, v13
    s_cmp_ge_u32 s52, 4000
    s_nop 3
    s_cbranch_scc1 L_B_ok3
    s_cbranch_vccnz L_B_fix3
    s_branch L_B_ok3
L_B_fix4:
    s_lshl_b32 s43, s28, 10
    s_add_u32 s43, s43, s41
    buffer_load_dwordx4 v[52:55], v2, s[16:19], s43 offen sc1
    s_add_u32 s52, s52, 1
    s_waitcnt vmcnt(0)
    v_max3_u32 v13, v52, v53, v54
    v_max_u32 v13, v13, v55
    v_cmp_eq_u32 vcc, -1, v13
    s_cmp_ge_u32 s52, 4000
    s_nop 3
    s_cbranch_scc1 L_B_ok4
    s_cbranch_vccnz L_B_fix4
    s_branch L_B_ok4
L_B_fix5:
    s_lshl_b32 s43, s29, 12
    s_add_u32 s43, s43, s3
    s_add_u32 s43, s43, 0
    buffer_load_dwordx4 v[56:59], v2, s[16:19], s43 offen sc1
    s_add_u32 s52, s52, 1
    s_waitcnt vmcnt(0)
    v_max3_u32 v13, v56, v57, v58
    v_max_u32 v13, v13, v59
    v_cmp_eq_u32 vcc, -1, v13
    s_cmp_ge_u32 s52, 4000
    s_nop 3
    s_cbranch_scc1 L_B_ok5
    s_cbranch_vccnz L_B_fix5
    s_branch L_B_ok5
L_B_fix6:
    s_lshl_b32 s43, s29, 12
    s_add_u32 s43, s43, s3
    s_add_u32 s43, s43, 1024
    buffer_load_dwordx4 v[60:63], v2, s[16:19], s43 offen sc1
    s_add_u32 s52, s52, 1
    s_waitcnt vmcnt(0)
    v_max3_u32 v13, v60, v61, v62
    v_max_u32 v13, v13, v63
    v_cmp_eq_u32 vcc, -1, v13
    s_cmp_ge_u32 s52, 4000
    s_nop 3
    s_cbranch_scc1 L_B_ok6
    s_cbranch_vccnz L_B_fix6
    s_branch L_B_ok6
L_B_fix7:
    s_lshl_b32 s43, s29, 12
    s_add_u32 s43, s43, s3
    s_add_u32 s43, s43, 2048
    buffer_load_dwordx4 v[64:67], v2, s[16:19], s43 offen sc1
    s_add_u32 s52, s52, 1
    s_waitcnt vmcnt(0)
    v_max3_u32 v13, v64, v65, v66
    v_max_u32 v13, v13, v67
    v_cmp_eq_u32 vcc, -1, v13
    s_cmp_ge_u32 s52, 4000
    s_nop 3
    s_cbranch_scc1 L_B_ok7
    s_cbranch_vccnz L_B_fix7
    s_branch L_B_ok7
L_B_fix8:
    s_lshl_b32 s43, s29, 12
    s_add_u32 s43, s43, s3
    s_add_u32 s43, s43, 3072
    buffer_load_dwordx4 v[68:71], v2, s[16:19], s43 offen sc1
    s_add_u32 s52, s52, 1
    s_waitcnt vmcnt(0)
    v_max3_u32 v13, v68, v69, v70
    v_max_u32 v13, v13, v71
    v_cmp_eq_u32 vcc, -1, v13
    s_cmp_ge_u32 s52, 4000
    s_nop 3
    s_cbranch_scc1 L_B_ok8
    s_cbranch_vccnz L_B_fix8
    s_branch L_B_ok8
L_B_fix9:
    s_lshl_b32 s43, s29, 10
    s_add_u32 s43, s43, s41
    buffer_load_dwordx4 v[72:75], v2, s[16:19], s43 offen sc1
    s_add_u32 s52, s52, 1
    s_waitcnt vmcnt(0)
    v_max3_u32 v13, v72, v73, v74
    v_max_u32 v13, v13, v75
    v_cmp_eq_u32 vcc, -1, v13
    s_cmp_ge_u32 s52, 4000
    s_nop 3
    s_cbranch_scc1 L_B_ok9
    s_cbranch_vccnz L_B_fix9
    s_branch L_B_ok9
L_B_fix10:
    s_lshl_b32 s43, s30, 12
    s_add_u32 s43, s43, s3
    s_add_u32 s43, s43, 0
    buffer_load_dwordx4 v[36:39], v2, s[16:19], s43 offen sc1
    s_add_u32 s52, s52, 1
    s_waitcnt vmcnt(0)
    v_max3_u32 v13, v36, v37, v38
    v_max_u32 v13, v13, v39
    v_cmp_eq_u32 vcc, -1, v13
    s_cmp_ge_u32 s52, 4000
    s_nop 3
    s_cbranch_scc1 L_B_ok10
    s_cbranch_vccnz L_B_fix10
    s_branch L_B_ok10
L_B_fix11:
    s_lshl_b32 s43, s30, 12
    s_add_u32 s43, s43, s3
    s_add_u32 s43, s43, 1024
    buffer_load_dwordx4 v[40:43], v2, s[16:19], s43 offen sc1
    s_add_u32 s52, s52, 1
    s_waitcnt vmcnt(0)
    v_max3_u32 v13, v40, v41, v42
    v_max_u32 v13, v13, v43
    v_cmp_eq_u32 vcc, -1, v13
    s_cmp_ge_u32 s52, 4000
    s_nop 3
    s_cbranch_scc1 L_B_ok11
    s_cbranch_vccnz L_B_fix11
    s_branch L_B_ok11
L_B_fix12:
    s_lshl_b32 s43, s30, 12
    s_add_u32 s43, s43, s3
    s_add_u32 s43, s43, 2048
    buffer_load_dwordx4 v[44:47], v2, s[16:19], s43 offen sc1
    s_add_u32 s52, s52, 1
    s_waitcnt vmcnt(0)
    v_max3_u32 v13, v44, v45, v46
    v_max_u32 v13, v13, v47
    v_cmp_eq_u32 vcc, -1, v13
    s_cmp_ge_u32 s52, 4000
    s_nop 3
    s_cbranch_scc1 L_B_ok12
    s_cbranch_vccnz L_B_fix12
    s_branch L_B_ok12
L_B_fix13:
    s_lshl_b32 s43, s30, 12
    s_add_u32 s43, s43, s3
    s_add_u32 s43, s43, 3072
    buffer_load_dwordx4 v[48:51], v2, s[16:19], s43 offen sc1
    s_add_u32 s52, s52, 1
    s_waitcnt vmcnt(0)
    v_max3_u32 v13, v48, v49, v50
    v_max_u32 v13, v13, v51
    v_cmp_eq_u32 vcc, -1, v13
    s_cmp_ge_u32 s52, 4000
    s_nop 3
    s_cbranch_scc1 L_B_ok13
    s_cbranch_vccnz L_B_fix13
    s_branch L_B_ok13
L_B_fix14:
    s_lshl_b32 s43, s30, 10
    s_add_u32 s43, s43, s41
    buffer_load_dwordx4 v[52:55], v2, s[16:19], s43 offen sc1
    s_add_u32 s52, s52, 1
    s_waitcnt vmcnt(0)
    v_max3_u32 v13, v52, v53, v54
    v_max_u32 v13, v13, v55
    v_cmp_eq_u32 vcc, -1, v13
    s_cmp_ge_u32 s52, 4000
    s_nop 3
    s_cbranch_scc1 L_B_ok14
    s_cbranch_vccnz L_B_fix14
    s_branch L_B_ok14
L_B_fix15:
    s_lshl_b32 s43, s31, 12
    s_add_u32 s43, s43, s3
    s_add_u32 s43, s43, 0
    buffer_load_dwordx4 v[56:59], v2, s[16:19], s43 offen sc1
    s_add_u32 s52, s52, 1
    s_waitcnt vmcnt(0)
    v_max3_u32 v13, v56, v57, v58
    v_max_u32 v13, v13, v59
    v_cmp_eq_u32 vcc, -1, v13
    s_cmp_ge_u32 s52, 4000
    s_nop 3
    s_cbranch_scc1 L_B_ok15
    s_cbranch_vccnz L_B_fix15
    s_branch L_B_ok15
L_B_fix16:
    s_lshl_b32 s43, s31, 12
    s_add_u32 s43, s43, s3
    s_add_u32 s43, s43, 1024
    buffer_load_dwordx4 v[60:63], v2, s[16:19], s43 offen sc1
    s_add_u32 s52, s52, 1
    s_waitcnt vmcnt(0)
    v_max3_u32 v13, v60, v61, v62
    v_max_u32 v13, v13, v63
    v_cmp_eq_u32 vcc, -1, v13
    s_cmp_ge_u32 s52, 4000
    s_nop 3
    s_cbranch_scc1 L_B_ok16
    s_cbranch_vccnz L_B_fix16
    s_branch L_B_ok16
L_B_fix17:
    s_lshl_b32 s43, s31, 12
    s_add_u32 s43, s43, s3
    s_add_u32 s43, s43, 2048
    buffer_load_dwordx4 v[64:67], v2, s[16:19], s43 offen sc1
    s_add_u32 s52, s52, 1
    s_waitcnt vmcnt(0)
    v_max3_u32 v13, v64, v65, v66
    v_max_u32 v13, v13, v67
    v_cmp_eq_u32 vcc, -1, v13
    s_cmp_ge_u32 s52, 4000
    s_nop 3
    s_cbranch_scc1 L_B_ok17
    s_cbranch_vccnz L_B_fix17
    s_branch L_B_ok17
L_B_fix18:
    s_lshl_b32 s43, s31, 12
    s_add_u32 s43, s43, s3
    s_add_u32 s43, s43, 3072
    buffer_load_dwordx4 v[68:71], v2, s[16:19], s43 offen sc1
    s_add_u32 s52, s52, 1
    s_waitcnt vmcnt(0)
    v_max3_u32 v13, v68, v69, v70
    v_max_u32 v13, v13, v71
    v_cmp_eq_u32 vcc, -1, v13
    s_cmp_ge_u32 s52, 4000
    s_nop 3
    s_cbranch_scc1 L_B_ok18
    s_cbranch_vccnz L_B_fix18
    s_branch L_B_ok18
L_B_fix19:
    s_lshl_b32 s43, s31, 10
    s_add_u32 s43, s43, s41
    buffer_load_dwordx4 v[72:75], v2, s[16:19], s43 offen sc1
    s_add_u32 s52, s52, 1
    s_waitcnt vmcnt(0)
    v_max3_u32 v13, v72, v73, v74
    v_max_u32 v13, v13, v75
    v_cmp_eq_u32 vcc, -1, v13
    s_cmp_ge_u32 s52, 4000
    s_nop 3
    s_cbranch_scc1 L_B_ok19
    s_cbranch_vccnz L_B_fix19
    s_branch L_B_ok19
.section .rodata,"a"
.p2align 6
.amdhsa_kernel concat_heads__ssm_conv_s4__linear_kernel_hedgehog__prompt_kernel
  .amdhsa_next_free_vgpr 256
  .amdhsa_next_free_sgpr 102
  .amdhsa_accum_offset 256
  .amdhsa_group_segment_fixed_size 0
  .amdhsa_kernarg_size 128
  .amdhsa_user_sgpr_count 2
  .amdhsa_user_sgpr_kernarg_segment_ptr 1
  .amdhsa_system_sgpr_workgroup_id_x 1
.end_amdhsa_kernel
```
